```python
import torch

def _softmax(x, axis=-1):
    return torch.softmax(x, dim=axis)
def _gelu(x):
    return torch.nn.functional.gelu(x, approximate="tanh")
def _silu(x):
    return torch.nn.functional.silu(x)
def _sigmoid(x):
    return torch.sigmoid(x)
def _layernorm(x, axis=-1, eps=1e-5):
    m = x.mean(dim=axis, keepdim=True)
    v = x.var(dim=axis, keepdim=True, unbiased=False)
    return (x - m) / torch.sqrt(v + eps)
def _scatter_add(tgt, idx, src, axis=0):
    return tgt.clone().index_add_(axis, idx, src)
def _segment_sum(src, seg, n):
    out = torch.zeros((n,) + src.shape[1:], dtype=src.dtype)
    return out.index_add_(0, seg, src)
def _pad(x, pw):
    flat = tuple(v for pair in reversed(pw) for v in pair)
    return torch.nn.functional.pad(x, flat)

kernel_name = 'standalone__gqa_block_cached__near_ridge'

def setup_inputs():

    _w = (lambda a: (lambda t: t.to(torch.bfloat16) if t.is_floating_point() else t)(torch.as_tensor(a)))
    B, Sq, D = 16, 128, 640
    Hq, Hkv, Sk, Dh = 32, 32, 1024, 128
    assert Hq % Hkv == 0, (Hq, Hkv)
    return {
        "x": _w((lambda *s: torch.randn(*s, dtype=torch.bfloat16) * 0.8)(B, Sq, D)),
        "k_cache": _w((lambda *s: torch.randn(*s, dtype=torch.bfloat16) * 0.8)(B, Hkv, Sk, Dh)),
        "v_cache": _w((lambda *s: torch.randn(*s, dtype=torch.bfloat16) * 0.05)(B, Hkv, Sk, Dh)),
        "wq": _w((lambda *s: torch.randn(*s, dtype=torch.bfloat16) * 0.8)(D, Hq * Dh) * (D ** -0.5)),
        "wo": _w((lambda *s: torch.randn(*s, dtype=torch.bfloat16) * 0.05)(Hq * Dh, D) * ((Hq * Dh) ** -0.5)),
    }

def reference(x, k_cache, v_cache, wq, wo):
    B, Sq, D = x.shape
    Hq, Dh = 32, 128
    Hkv = k_cache.shape[1]
    rep = Hq // Hkv
    q = (lambda x, *d: x.permute(*d))((x @ wq).reshape(B, Sq, Hq, Dh), 0, 2, 1, 3)
    k = (lambda x, n, axis: torch.repeat_interleave(x, n, dim=axis))(k_cache, rep, axis=1)
    v = (lambda x, n, axis: torch.repeat_interleave(x, n, dim=axis))(v_cache, rep, axis=1)
    scores = torch.einsum("bhqd,bhkd->bhqk", q, k) * (Dh ** -0.5)
    p = _softmax(scores, axis=-1)
    o = torch.einsum("bhqk,bhkd->bhqd", p, v)
    return (lambda x, *d: x.permute(*d))(o, 0, 2, 1, 3).reshape(B, Sq, Hq * Dh) @ wo
```

```asm
; @launch grid=(256,1,1) block=(512,1,1) lds=163840
.amdgcn_target "amdgcn-amd-amdhsa--gfx950"
.text
.globl standalone__gqa_block_cached__near_ridge_kernel
.p2align 8
.type standalone__gqa_block_cached__near_ridge_kernel,@function
standalone__gqa_block_cached__near_ridge_kernel:
L_start:
    s_cmp_ge_u32 s2, 256
    s_cbranch_scc1 L_end
    s_load_dwordx16 s[36:51], s[0:1], 0
    v_lshrrev_b32 v1, 6, v0
    v_and_b32 v249, 63, v0
    v_readfirstlane_b32 s33, v1
    s_and_b32 s66, s2, 1
    s_lshl_b32 s66, s66, 3
    s_bfe_u32 s5, s2, 0x30003
    s_add_u32 s5, s5, s66
    s_bfe_u32 s66, s2, 0x20001
    s_lshl_b32 s66, s66, 2
    s_lshr_b32 s6, s2, 6
    s_add_u32 s6, s6, s66
    s_lshr_b32 s4, s33, 2
    s_and_b32 s3, s33, 3
    s_lshl_b32 s68, s3, 12
    s_lshl_b32 s52, s5, 4
    s_add_u32 s52, s52, s6
    s_lshl_b32 s52, s52, 19
    s_add_u32 s52, s52, s68
    s_mov_b32 s7, 0x8000
    s_mov_b32 s61, 0x3e0293ee
    s_mov_b32 s62, 0x41000000
    v_lshrrev_b32 v250, 5, v249
    v_and_b32 v251, 15, v249
    v_bfe_u32 v252, v249, 4, 1
    v_lshlrev_b32 v252, 8, v252
    v_lshl_add_u32 v252, v250, 13, v252
    s_and_b32 s66, s33, 2
    s_lshl_b32 s66, s66, 1
    v_add_u32 v250, s66, v250
    v_add_u32 v253, 0, v250
    v_lshlrev_b32 v253, 1, v253
    v_xor_b32 v253, v253, v251
    v_lshl_add_u32 v92, v253, 4, v252
    v_add_u32 v253, 2, v250
    v_lshlrev_b32 v253, 1, v253
    v_xor_b32 v253, v253, v251
    v_lshl_add_u32 v93, v253, 4, v252
    v_add_u32 v93, 15360, v93
    v_lshrrev_b32 v250, 4, v249
    v_lshrrev_b32 v252, 3, v249
    v_mul_u32_u24 v252, 1280, v252
    v_and_b32 v251, 7, v249
    v_add_u32 v253, 0, v250
    v_xor_b32 v253, v253, v251
    v_lshl_add_u32 v90, v253, 4, v252
    v_add_u32 v253, 4, v250
    v_xor_b32 v253, v253, v251
    v_lshl_add_u32 v91, v253, 4, v252
    v_add_u32 v91, 9216, v91
    s_lshl_b32 s79, s33, 11
    s_lshl_b32 s56, s5, 3
    s_add_u32 s56, s56, s33
    s_mul_i32 s56, s56, 20480
    s_lshl_b32 s57, s33, 15
    s_lshl_b32 s66, s6, 9
    s_add_u32 s57, s57, s66
    s_waitcnt lgkmcnt(0)
    s_mov_b32 s16, s36
    s_mov_b32 s17, s37
    s_mov_b32 s18, 2621440
    s_mov_b32 s19, 0x20000
    s_mov_b32 s20, s42
    s_mov_b32 s21, s43
    s_mov_b32 s22, 5242880
    s_mov_b32 s23, 0x20000
    s_add_u32 m0, s79, 81920
    s_add_u32 s64, s56, 0
    buffer_load_dwordx4 v90, s[16:19], s64 offen offset:0 lds
    buffer_load_dwordx4 v91, s[16:19], s64 offen offset:1024 lds
    s_add_u32 m0, s79, 32768
    s_add_u32 s64, s57, 0
    buffer_load_dwordx4 v92, s[20:23], s64 offen offset:0 lds
    buffer_load_dwordx4 v93, s[20:23], s64 offen offset:1024 lds
    s_add_u32 m0, s79, 98304
    s_add_u32 s64, s57, 262144
    buffer_load_dwordx4 v92, s[20:23], s64 offen offset:0 lds
    buffer_load_dwordx4 v93, s[20:23], s64 offen offset:1024 lds
    v_bfe_u32 v250, v249, 2, 2
    v_lshrrev_b32 v251, 4, v249
    v_lshl_add_u32 v251, v251, 3, v250
    v_lshlrev_b32 v251, 9, v251
    v_and_b32 v252, 1, v249
    v_lshl_add_u32 v251, v252, 3, v251
    s_lshl_b32 s66, s4, 8
    s_add_u32 s66, s66, 32768
    v_add_u32 v251, s66, v251
    s_getpc_b64 s[88:89]
L_pc0:
    s_add_u32 s88, s88, L_start-L_pc0
    s_addc_u32 s89, s89, -1
    s_lshr_b32 s70, s2, 3
    s_lshl_b32 s70, s70, 10
    s_min_u32 s70, s70, L_stop-L_start-1024
    v_lshlrev_b32 v152, 4, v249
    v_add_u32 v152, s70, v152
    global_load_dwordx4 v[152:155], v152, s[88:89]
    v_bfe_u32 v252, v249, 4, 1
    v_lshl_add_u32 v250, v252, 2, v250
    v_bfe_u32 v252, v249, 1, 1
    v_lshl_add_u32 v250, v250, 1, v252
    v_xor_b32 v253, 0, v250
    v_lshl_add_u32 v80, v253, 4, v251
    s_add_u32 m0, s79, 49152
    s_add_u32 s64, s56, 128
    buffer_load_dwordx4 v90, s[16:19], s64 offen offset:0 lds
    buffer_load_dwordx4 v91, s[16:19], s64 offen offset:1024 lds
    v_add_u32 v192, 65536, v80
    v_xor_b32 v253, 2, v250
    v_lshl_add_u32 v81, v253, 4, v251
    v_add_u32 v193, 65536, v81
    v_xor_b32 v253, 4, v250
    v_lshl_add_u32 v82, v253, 4, v251
    v_add_u32 v194, 65536, v82
    s_add_u32 m0, s79, 114688
    s_add_u32 s64, s57, 524288
    buffer_load_dwordx4 v92, s[20:23], s64 offen offset:0 lds
    buffer_load_dwordx4 v93, s[20:23], s64 offen offset:1024 lds
    v_xor_b32 v253, 6, v250
    v_lshl_add_u32 v83, v253, 4, v251
    v_add_u32 v195, 65536, v83
    v_xor_b32 v253, 8, v250
    v_lshl_add_u32 v84, v253, 4, v251
    v_add_u32 v196, 65536, v84
    s_add_u32 m0, s79, 131072
    s_add_u32 s64, s57, 786432
    buffer_load_dwordx4 v92, s[20:23], s64 offen offset:0 lds
    buffer_load_dwordx4 v93, s[20:23], s64 offen offset:1024 lds
    v_xor_b32 v253, 10, v250
    v_lshl_add_u32 v85, v253, 4, v251
    v_add_u32 v197, 65536, v85
    v_xor_b32 v253, 12, v250
    v_lshl_add_u32 v86, v253, 4, v251
    v_add_u32 v198, 65536, v86
    v_xor_b32 v253, 14, v250
    s_add_u32 m0, s79, 65536
    s_add_u32 s64, s56, 256
    buffer_load_dwordx4 v90, s[16:19], s64 offen offset:0 lds
    buffer_load_dwordx4 v91, s[16:19], s64 offen offset:1024 lds
    v_lshl_add_u32 v87, v253, 4, v251
    v_add_u32 v199, 65536, v87
    v_and_b32 v250, 15, v249
    v_lshlrev_b32 v250, 7, v250
    s_add_u32 s66, s68, 49152
    v_add_u32 v250, s66, v250
    s_add_u32 m0, s79, 147456
    s_add_u32 s64, s57, 1048576
    buffer_load_dwordx4 v92, s[20:23], s64 offen offset:0 lds
    buffer_load_dwordx4 v93, s[20:23], s64 offen offset:1024 lds
    v_lshrrev_b32 v251, 4, v249
    v_bfe_u32 v252, v249, 1, 3
    v_xor_b32 v252, v252, v251
    v_xor_b32 v253, 0, v252
    v_lshl_add_u32 v88, v253, 4, v250
    v_xor_b32 v253, 4, v252
    v_lshl_add_u32 v89, v253, 4, v250
    s_cmp_eq_u32 s4, 0
    s_cselect_b64 vcc, 0, -1
    s_waitcnt vmcnt(13)
    s_barrier
    ds_read_b128 v[64:67], v88 offset:32768
    ds_read_b64_tr_b16 v[160:161], v80 offset:0
    ds_read_b64_tr_b16 v[162:163], v80 offset:2048
    ds_read_b128 v[68:71], v88 offset:34816
    ds_read_b64_tr_b16 v[164:165], v81 offset:0
    ds_read_b64_tr_b16 v[166:167], v81 offset:2048
    ds_read_b64_tr_b16 v[168:169], v82 offset:0
    ds_read_b64_tr_b16 v[170:171], v82 offset:2048
    ds_read_b64_tr_b16 v[172:173], v83 offset:0
    ds_read_b64_tr_b16 v[174:175], v83 offset:2048
    ds_read_b64_tr_b16 v[176:177], v84 offset:0
    ds_read_b64_tr_b16 v[178:179], v84 offset:2048
    ds_read_b64_tr_b16 v[180:181], v85 offset:0
    ds_read_b64_tr_b16 v[182:183], v85 offset:2048
    ds_read_b64_tr_b16 v[184:185], v86 offset:0
    s_waitcnt lgkmcnt(14)
    ds_read_b64_tr_b16 v[186:187], v86 offset:2048
    s_waitcnt lgkmcnt(14)
    ds_read_b64_tr_b16 v[188:189], v87 offset:0
    s_waitcnt lgkmcnt(14)
    ds_read_b64_tr_b16 v[190:191], v87 offset:2048
    s_mov_b32 s24, s44
    s_mov_b32 s25, s45
    s_mov_b32 s26, 5242880
    s_mov_b32 s27, 0x20000
    s_lshr_b32 s86, s2, 1
    s_mul_i32 s86, s86, 40960
    s_and_b32 s66, s2, 1
    s_mul_i32 s66, s66, 640
    s_add_u32 s86, s86, s66
    v_mov_b32 v203, 640
    s_mul_i32 s66, s33, 3
    s_add_u32 s66, s66, 0
    s_min_u32 s66, s66, 19
    s_lshl_b32 s66, s66, 6
    v_add_u32 v250, s66, v249
    v_mul_u32_u24 v251, 1639, v250
    v_lshlrev_b32 v250, 4, v250
    v_lshrrev_b32 v251, 16, v251
    v_mad_u32_u24 v202, v251, v203, v250
    s_lshl_b32 m0, s66, 4
    s_nop 0
    buffer_load_dwordx4 v202, s[24:27], s86 offen lds
    s_mul_i32 s66, s33, 3
    s_add_u32 s66, s66, 1
    s_min_u32 s66, s66, 19
    s_lshl_b32 s66, s66, 6
    v_add_u32 v250, s66, v249
    v_mul_u32_u24 v251, 1639, v250
    v_lshlrev_b32 v250, 4, v250
    v_lshrrev_b32 v251, 16, v251
    v_mad_u32_u24 v202, v251, v203, v250
    s_lshl_b32 m0, s66, 4
    s_nop 0
    buffer_load_dwordx4 v202, s[24:27], s86 offen lds
    s_mul_i32 s66, s33, 3
    s_add_u32 s66, s66, 2
    s_min_u32 s66, s66, 19
    s_lshl_b32 s66, s66, 6
    v_add_u32 v250, s66, v249
    v_mul_u32_u24 v251, 1639, v250
    v_lshlrev_b32 v250, 4, v250
    v_lshrrev_b32 v251, 16, v251
    v_mad_u32_u24 v202, v251, v203, v250
    s_lshl_b32 m0, s66, 4
    s_nop 0
    buffer_load_dwordx4 v202, s[24:27], s86 offen lds
    s_waitcnt lgkmcnt(0)
    s_waitcnt vmcnt(14)
    s_barrier
    v_mfma_f32_16x16x32_bf16 v[0:3], v[160:163], v[64:67], 0
    ds_read_b128 v[72:75], v89 offset:32768
    ds_read_b64_tr_b16 v[96:97], v192 offset:0
    v_mfma_f32_16x16x32_bf16 v[4:7], v[160:163], v[68:71], 0
    ds_read_b64_tr_b16 v[98:99], v192 offset:2048
    v_lshrrev_b32 v250, 4, v249
    v_and_b32 v251, 15, v249
    v_lshlrev_b32 v252, 8, v250
    v_add_u32 v253, 0, v250
    v_xor_b32 v253, v253, v251
    v_lshl_add_u32 v216, v253, 4, v252
    v_add_u32 v253, 4, v250
    v_xor_b32 v253, v253, v251
    v_lshl_add_u32 v217, v253, 4, v252
    v_add_u32 v253, 8, v250
    v_xor_b32 v253, v253, v251
    v_lshl_add_u32 v218, v253, 4, v252
    v_add_u32 v253, 12, v250
    v_xor_b32 v253, v253, v251
    v_lshl_add_u32 v219, v253, 4, v252
    v_add_u32 v253, 0, v250
    v_lshlrev_b32 v253, 1, v253
    v_xor_b32 v253, v253, v251
    v_lshl_add_u32 v220, v253, 4, v252
    v_add_u32 v253, 4, v250
    v_mfma_f32_16x16x32_bf16 v[8:11], v[164:167], v[64:67], 0
    ds_read_b128 v[76:79], v89 offset:34816
    ds_read_b64_tr_b16 v[100:101], v193 offset:0
    v_mfma_f32_16x16x32_bf16 v[12:15], v[164:167], v[68:71], 0
    ds_read_b64_tr_b16 v[102:103], v193 offset:2048
    v_lshlrev_b32 v253, 1, v253
    v_xor_b32 v253, v253, v251
    v_lshl_add_u32 v221, v253, 4, v252
    s_bitcmp1_b32 s33, 0
    s_cselect_b64 s[90:91], -1, 0
    v_cndmask_b32 v94, v216, v218, s[90:91]
    v_cndmask_b32 v95, v217, v219, s[90:91]
    s_mov_b32 s8, s38
    s_mov_b32 s9, s39
    s_mov_b32 s10, 134217728
    s_mov_b32 s11, 0x20000
    s_mov_b32 s12, s40
    s_mov_b32 s13, s41
    s_mov_b32 s14, 134217728
    s_mov_b32 s15, 0x20000
    s_sub_u32 s76, s52, s68
    s_add_u32 s76, s76, s79
    v_lshrrev_b32 v250, 2, v249
    v_mul_u32_u24 v250, 640, v250
    v_and_b32 v251, 3, v249
    v_lshl_add_u32 v250, v251, 3, v250
    v_mfma_f32_16x16x32_bf16 v[16:19], v[168:171], v[64:67], 0
    ds_read_b64_tr_b16 v[104:105], v194 offset:0
    v_mfma_f32_16x16x32_bf16 v[20:23], v[168:171], v[68:71], 0
    ds_read_b64_tr_b16 v[106:107], v194 offset:2048
    s_min_u32 s66, s33, 6
    s_mul_i32 s66, s66, 96
    v_add_u32 v250, s66, v250
    v_mfma_f32_16x16x32_bf16 v[24:27], v[172:175], v[64:67], 0
    ds_read_b64_tr_b16 v[108:109], v195 offset:0
    v_mfma_f32_16x16x32_bf16 v[28:31], v[172:175], v[68:71], 0
    ds_read_b64_tr_b16 v[110:111], v195 offset:2048
    s_add_u32 m0, s79, 32768
    s_add_u32 s64, s57, 1310720
    buffer_load_dwordx4 v92, s[20:23], s64 offen offset:0 lds
    v_mfma_f32_16x16x32_bf16 v[32:35], v[176:179], v[64:67], 0
    ds_read_b64_tr_b16 v[112:113], v196 offset:0
    v_mfma_f32_16x16x32_bf16 v[36:39], v[176:179], v[68:71], 0
    ds_read_b64_tr_b16 v[114:115], v196 offset:2048
    v_mfma_f32_16x16x32_bf16 v[40:43], v[180:183], v[64:67], 0
    ds_read_b64_tr_b16 v[116:117], v197 offset:0
    v_mfma_f32_16x16x32_bf16 v[44:47], v[180:183], v[68:71], 0
    ds_read_b64_tr_b16 v[118:119], v197 offset:2048
    v_mfma_f32_16x16x32_bf16 v[48:51], v[184:187], v[64:67], 0
    ds_read_b64_tr_b16 v[120:121], v198 offset:0
    s_waitcnt lgkmcnt(14)
    ds_read_b64_tr_b16 v[122:123], v198 offset:2048
    v_mfma_f32_16x16x32_bf16 v[52:55], v[184:187], v[68:71], 0
    s_waitcnt lgkmcnt(14)
    ds_read_b64_tr_b16 v[124:125], v199 offset:0
    s_waitcnt lgkmcnt(14)
    ds_read_b64_tr_b16 v[126:127], v199 offset:2048
    v_mfma_f32_16x16x32_bf16 v[56:59], v[188:191], v[64:67], 0
    v_mfma_f32_16x16x32_bf16 v[60:63], v[188:191], v[68:71], 0
    buffer_load_dwordx4 v93, s[20:23], s64 offen offset:1024 lds
    s_waitcnt lgkmcnt(0)
    s_waitcnt vmcnt(2)
    s_barrier
    v_mfma_f32_16x16x32_bf16 v[0:3], v[96:99], v[72:75], v[0:3]
    ds_read_b128 v[64:67], v88 offset:0
    ds_read_b64_tr_b16 v[160:161], v192 offset:16384
    v_mfma_f32_16x16x32_bf16 v[4:7], v[96:99], v[76:79], v[4:7]
    ds_read_b64_tr_b16 v[162:163], v192 offset:18432
    ds_read_b64_tr_b16 v[128:129], v250 offset:0
    ds_read_b64_tr_b16 v[130:131], v250 offset:10240
    ds_read_b64_tr_b16 v[132:133], v250 offset:32
    ds_read_b64_tr_b16 v[134:135], v250 offset:10272
    ds_read_b64_tr_b16 v[136:137], v250 offset:64
    ds_read_b64_tr_b16 v[138:139], v250 offset:10304
    s_mov_b32 s28, s50
    s_mov_b32 s29, s51
    s_mov_b32 s30, 22052864
    s_mov_b32 s31, 0x20000
    s_lshl_b32 s80, s5, 4
    s_add_u32 s80, s80, s6
    s_lshl_b32 s80, s80, 7
    s_add_u32 s80, s80, 22020096
    v_lshlrev_b32 v202, 4, v249
    s_bfe_u32 s86, s2, 0x10003
    s_lshl_b32 s86, s86, 4
    s_lshr_b32 s66, s2, 4
    s_add_u32 s86, s86, s66
    s_lshl_b32 s86, s86, 2
    v_mfma_f32_16x16x32_bf16 v[8:11], v[100:103], v[72:75], v[8:11]
    ds_read_b128 v[68:71], v88 offset:2048
    ds_read_b64_tr_b16 v[164:165], v193 offset:16384
    v_mfma_f32_16x16x32_bf16 v[12:15], v[100:103], v[76:79], v[12:15]
    ds_read_b64_tr_b16 v[166:167], v193 offset:18432
    s_bfe_u32 s66, s2, 0x20001
    s_add_u32 s86, s86, s66
    s_mul_i32 s86, s86, 5120
    s_and_b32 s66, s2, 1
    s_mul_i32 s66, s66, 2621440
    s_add_u32 s86, s86, s66
    s_add_u32 s86, s86, 16777216
    s_lshr_b32 s66, s3, 1
    s_lshl_b32 s69, s5, 1
    s_add_u32 s69, s69, s66
    s_lshl_b32 s69, s69, 1
    s_add_u32 s69, s69, s4
    s_lshl_b32 s69, s69, 4
    s_add_u32 s69, s69, s6
    s_lshl_b32 s69, s69, 14
    s_and_b32 s66, s3, 1
    s_lshl_b32 s66, s66, 11
    s_add_u32 s69, s69, s66
    s_lshl_b32 s63, s4, 15
    v_lshrrev_b32 v250, 2, v249
    v_mfma_f32_16x16x32_bf16 v[16:19], v[104:107], v[72:75], v[16:19]
    ds_read_b64_tr_b16 v[168:169], v194 offset:16384
    v_mfma_f32_16x16x32_bf16 v[20:23], v[104:107], v[76:79], v[20:23]
    ds_read_b64_tr_b16 v[170:171], v194 offset:18432
    s_add_u32 m0, s79, 81920
    s_add_u32 s64, s56, 384
    buffer_load_dwordx4 v90, s[16:19], s64 offen offset:0 lds
    v_lshlrev_b32 v251, 8, v250
    v_and_b32 v252, 1, v249
    v_lshl_add_u32 v251, v252, 3, v251
    s_add_u32 s66, s63, 16384
    v_add_u32 v251, s66, v251
    v_and_b32 v250, 7, v250
    v_bfe_u32 v252, v249, 1, 1
    v_lshl_add_u32 v250, v250, 1, v252
    v_xor_b32 v253, 0, v250
    v_lshl_add_u32 v228, v253, 4, v251
    v_xor_b32 v253, 2, v250
    v_lshl_add_u32 v229, v253, 4, v251
    v_xor_b32 v253, 4, v250
    v_lshl_add_u32 v230, v253, 4, v251
    v_xor_b32 v253, 6, v250
    v_lshl_add_u32 v231, v253, 4, v251
    v_xor_b32 v253, 8, v250
    v_lshl_add_u32 v232, v253, 4, v251
    v_xor_b32 v253, 10, v250
    v_lshl_add_u32 v233, v253, 4, v251
    v_mfma_f32_16x16x32_bf16 v[24:27], v[108:111], v[72:75], v[24:27]
    ds_read_b64_tr_b16 v[172:173], v195 offset:16384
    v_mfma_f32_16x16x32_bf16 v[28:31], v[108:111], v[76:79], v[28:31]
    s_waitcnt lgkmcnt(14)
    ds_read_b64_tr_b16 v[174:175], v195 offset:18432
    v_xor_b32 v253, 12, v250
    v_lshl_add_u32 v234, v253, 4, v251
    v_xor_b32 v253, 14, v250
    v_lshl_add_u32 v235, v253, 4, v251
    v_and_b32 v250, 15, v249
    v_lshrrev_b32 v251, 4, v249
    v_xor_b32 v251, v251, v250
    v_lshlrev_b32 v250, 8, v250
    v_add_u32 v250, s63, v250
    v_xor_b32 v253, 0, v251
    v_lshl_add_u32 v224, v253, 4, v250
    v_xor_b32 v253, 4, v251
    v_lshl_add_u32 v225, v253, 4, v250
    v_xor_b32 v253, 8, v251
    v_lshl_add_u32 v226, v253, 4, v250
    v_xor_b32 v253, 12, v251
    v_lshl_add_u32 v227, v253, 4, v250
    v_mfma_f32_16x16x32_bf16 v[32:35], v[112:115], v[72:75], v[32:35]
    s_waitcnt lgkmcnt(14)
    ds_read_b64_tr_b16 v[176:177], v196 offset:16384
    v_mfma_f32_16x16x32_bf16 v[36:39], v[112:115], v[76:79], v[36:39]
    s_waitcnt lgkmcnt(14)
    ds_read_b64_tr_b16 v[178:179], v196 offset:18432
    v_mfma_f32_16x16x32_bf16 v[40:43], v[116:119], v[72:75], v[40:43]
    s_waitcnt lgkmcnt(14)
    ds_read_b64_tr_b16 v[180:181], v197 offset:16384
    v_mfma_f32_16x16x32_bf16 v[44:47], v[116:119], v[76:79], v[44:47]
    s_waitcnt lgkmcnt(14)
    ds_read_b64_tr_b16 v[182:183], v197 offset:18432
    s_add_u32 m0, s79, 98304
    s_add_u32 s64, s57, 1572864
    buffer_load_dwordx4 v92, s[20:23], s64 offen offset:0 lds
    v_mfma_f32_16x16x32_bf16 v[48:51], v[120:123], v[72:75], v[48:51]
    s_waitcnt lgkmcnt(14)
    ds_read_b64_tr_b16 v[184:185], v198 offset:16384
    s_waitcnt lgkmcnt(14)
    ds_read_b64_tr_b16 v[186:187], v198 offset:18432
    v_mfma_f32_16x16x32_bf16 v[52:55], v[120:123], v[76:79], v[52:55]
    s_waitcnt lgkmcnt(14)
    ds_read_b64_tr_b16 v[188:189], v199 offset:16384
    s_waitcnt lgkmcnt(14)
    ds_read_b64_tr_b16 v[190:191], v199 offset:18432
    v_mfma_f32_16x16x32_bf16 v[56:59], v[124:127], v[72:75], v[56:59]
    v_mfma_f32_16x16x32_bf16 v[60:63], v[124:127], v[76:79], v[60:63]
    buffer_load_dwordx4 v93, s[20:23], s64 offen offset:1024 lds
    s_waitcnt lgkmcnt(0)
    s_waitcnt vmcnt(12)
    s_barrier
    v_mfma_f32_16x16x32_bf16 v[0:3], v[160:163], v[64:67], v[0:3]
    ds_read_b128 v[72:75], v89 offset:0
    ds_read_b64_tr_b16 v[96:97], v192 offset:32768
    v_mfma_f32_16x16x32_bf16 v[4:7], v[160:163], v[68:71], v[4:7]
    ds_read_b64_tr_b16 v[98:99], v192 offset:34816
    v_mfma_f32_16x16x32_bf16 v[8:11], v[164:167], v[64:67], v[8:11]
    ds_read_b128 v[76:79], v89 offset:2048
    ds_read_b64_tr_b16 v[100:101], v193 offset:32768
    v_mfma_f32_16x16x32_bf16 v[12:15], v[164:167], v[68:71], v[12:15]
    ds_read_b64_tr_b16 v[102:103], v193 offset:34816
    v_mfma_f32_16x16x32_bf16 v[16:19], v[168:171], v[64:67], v[16:19]
    ds_read_b64_tr_b16 v[104:105], v194 offset:32768
    v_mfma_f32_16x16x32_bf16 v[20:23], v[168:171], v[68:71], v[20:23]
    ds_read_b64_tr_b16 v[106:107], v194 offset:34816
    s_add_u32 m0, s79, 81920
    s_add_u32 s64, s56, 384
    buffer_load_dwordx4 v91, s[16:19], s64 offen offset:1024 lds
    v_mfma_f32_16x16x32_bf16 v[24:27], v[172:175], v[64:67], v[24:27]
    ds_read_b64_tr_b16 v[108:109], v195 offset:32768
    v_mfma_f32_16x16x32_bf16 v[28:31], v[172:175], v[68:71], v[28:31]
    ds_read_b64_tr_b16 v[110:111], v195 offset:34816
    v_mfma_f32_16x16x32_bf16 v[32:35], v[176:179], v[64:67], v[32:35]
    ds_read_b64_tr_b16 v[112:113], v196 offset:32768
    v_mfma_f32_16x16x32_bf16 v[36:39], v[176:179], v[68:71], v[36:39]
    ds_read_b64_tr_b16 v[114:115], v196 offset:34816
    v_mfma_f32_16x16x32_bf16 v[40:43], v[180:183], v[64:67], v[40:43]
    ds_read_b64_tr_b16 v[116:117], v197 offset:32768
    v_mfma_f32_16x16x32_bf16 v[44:47], v[180:183], v[68:71], v[44:47]
    ds_read_b64_tr_b16 v[118:119], v197 offset:34816
    s_add_u32 m0, s79, 114688
    s_add_u32 s64, s57, 1835008
    buffer_load_dwordx4 v92, s[20:23], s64 offen offset:0 lds
    v_mfma_f32_16x16x32_bf16 v[48:51], v[184:187], v[64:67], v[48:51]
    ds_read_b64_tr_b16 v[120:121], v198 offset:32768
    s_waitcnt lgkmcnt(14)
    ds_read_b64_tr_b16 v[122:123], v198 offset:34816
    v_mfma_f32_16x16x32_bf16 v[52:55], v[184:187], v[68:71], v[52:55]
    s_waitcnt lgkmcnt(14)
    ds_read_b64_tr_b16 v[124:125], v199 offset:32768
    s_waitcnt lgkmcnt(14)
    ds_read_b64_tr_b16 v[126:127], v199 offset:34816
    v_mfma_f32_16x16x32_bf16 v[56:59], v[188:191], v[64:67], v[56:59]
    v_mfma_f32_16x16x32_bf16 v[60:63], v[188:191], v[68:71], v[60:63]
    buffer_load_dwordx4 v93, s[20:23], s64 offen offset:1024 lds
    s_waitcnt lgkmcnt(0)
    s_waitcnt vmcnt(11)
    s_barrier
    v_mfma_f32_16x16x32_bf16 v[0:3], v[96:99], v[72:75], v[0:3]
    ds_read_b128 v[64:67], v88 offset:16384
    ds_read_b64_tr_b16 v[160:161], v192 offset:49152
    v_mfma_f32_16x16x32_bf16 v[4:7], v[96:99], v[76:79], v[4:7]
    ds_read_b64_tr_b16 v[162:163], v192 offset:51200
    v_mfma_f32_16x16x32_bf16 v[8:11], v[100:103], v[72:75], v[8:11]
    ds_read_b128 v[68:71], v88 offset:18432
    ds_read_b64_tr_b16 v[164:165], v193 offset:49152
    v_mfma_f32_16x16x32_bf16 v[12:15], v[100:103], v[76:79], v[12:15]
    ds_read_b64_tr_b16 v[166:167], v193 offset:51200
    s_add_u32 m0, s79, 49152
    s_add_u32 s64, s56, 512
    buffer_load_dwordx4 v90, s[16:19], s64 offen offset:0 lds
    v_mfma_f32_16x16x32_bf16 v[16:19], v[104:107], v[72:75], v[16:19]
    ds_read_b64_tr_b16 v[168:169], v194 offset:49152
    v_mfma_f32_16x16x32_bf16 v[20:23], v[104:107], v[76:79], v[20:23]
    ds_read_b64_tr_b16 v[170:171], v194 offset:51200
    v_mfma_f32_16x16x32_bf16 v[24:27], v[108:111], v[72:75], v[24:27]
    ds_read_b64_tr_b16 v[172:173], v195 offset:49152
    v_mfma_f32_16x16x32_bf16 v[28:31], v[108:111], v[76:79], v[28:31]
    ds_read_b64_tr_b16 v[174:175], v195 offset:51200
    s_add_u32 m0, s79, 131072
    s_add_u32 s64, s57, 2097152
    buffer_load_dwordx4 v92, s[20:23], s64 offen offset:0 lds
    v_mfma_f32_16x16x32_bf16 v[32:35], v[112:115], v[72:75], v[32:35]
    ds_read_b64_tr_b16 v[176:177], v196 offset:49152
    v_mfma_f32_16x16x32_bf16 v[36:39], v[112:115], v[76:79], v[36:39]
    ds_read_b64_tr_b16 v[178:179], v196 offset:51200
    v_mfma_f32_16x16x32_bf16 v[40:43], v[116:119], v[72:75], v[40:43]
    ds_read_b64_tr_b16 v[180:181], v197 offset:49152
    v_mfma_f32_16x16x32_bf16 v[44:47], v[116:119], v[76:79], v[44:47]
    ds_read_b64_tr_b16 v[182:183], v197 offset:51200
    buffer_load_dwordx4 v93, s[20:23], s64 offen offset:1024 lds
    v_mfma_f32_16x16x32_bf16 v[48:51], v[120:123], v[72:75], v[48:51]
    ds_read_b64_tr_b16 v[184:185], v198 offset:49152
    s_waitcnt lgkmcnt(14)
    ds_read_b64_tr_b16 v[186:187], v198 offset:51200
    v_mfma_f32_16x16x32_bf16 v[52:55], v[120:123], v[76:79], v[52:55]
    s_waitcnt lgkmcnt(14)
    ds_read_b64_tr_b16 v[188:189], v199 offset:49152
    s_waitcnt lgkmcnt(14)
    ds_read_b64_tr_b16 v[190:191], v199 offset:51200
    v_mfma_f32_16x16x32_bf16 v[56:59], v[124:127], v[72:75], v[56:59]
    v_mfma_f32_16x16x32_bf16 v[60:63], v[124:127], v[76:79], v[60:63]
    s_add_u32 m0, s79, 0
    s_add_u32 s64, s76, 0
    buffer_load_dwordx4 v94, s[8:11], s64 offen offset:0 nt lds
    s_lshr_b32 s65, s33, 1
    s_cmp_lg_u32 s65, 0
    s_cbranch_scc1 L_st3
    s_mul_i32 s70, s33, 3
    s_add_u32 s70, s70, 0
    s_mul_i32 s71, s70, 205
    s_lshr_b32 s71, s71, 10
    s_mul_i32 s71, s71, 650240
    s_add_u32 s71, s71, s86
    s_lshl_b32 s65, s70, 10
    s_add_u32 s71, s71, s65
    s_cmp_lt_u32 s70, 20
    s_cselect_b32 s71, s71, 2130706432
    buffer_store_dwordx4 v[128:131], v202, s[28:31], s71 offen sc1
L_st3:
    s_cmp_lg_u32 s33, 4
    s_cbranch_scc1 L_z
    s_mov_b64 exec, 1
    v_mov_b32 v236, 0
    v_mov_b32 v237, 0
    buffer_store_dwordx2 v[236:237], off, s[28:31], s80 sc1
    s_mov_b64 exec, -1
L_z:
    s_waitcnt lgkmcnt(0)
    s_waitcnt vmcnt(10)
    s_barrier
    v_mfma_f32_16x16x32_bf16 v[0:3], v[160:163], v[64:67], v[0:3]
    ds_read_b128 v[72:75], v89 offset:16384
    ds_read_b64_tr_b16 v[96:97], v80 offset:0
    v_mfma_f32_16x16x32_bf16 v[4:7], v[160:163], v[68:71], v[4:7]
    ds_read_b64_tr_b16 v[98:99], v80 offset:2048
    v_mfma_f32_16x16x32_bf16 v[8:11], v[164:167], v[64:67], v[8:11]
    ds_read_b128 v[76:79], v89 offset:18432
    ds_read_b64_tr_b16 v[100:101], v81 offset:0
    v_mfma_f32_16x16x32_bf16 v[12:15], v[164:167], v[68:71], v[12:15]
    ds_read_b64_tr_b16 v[102:103], v81 offset:2048
    s_add_u32 m0, s79, 49152
    s_add_u32 s64, s56, 512
    buffer_load_dwordx4 v91, s[16:19], s64 offen offset:1024 lds
    v_mfma_f32_16x16x32_bf16 v[16:19], v[168:171], v[64:67], v[16:19]
    ds_read_b64_tr_b16 v[104:105], v82 offset:0
    v_mfma_f32_16x16x32_bf16 v[20:23], v[168:171], v[68:71], v[20:23]
    ds_read_b64_tr_b16 v[106:107], v82 offset:2048
    v_mfma_f32_16x16x32_bf16 v[24:27], v[172:175], v[64:67], v[24:27]
    ds_read_b64_tr_b16 v[108:109], v83 offset:0
    v_mfma_f32_16x16x32_bf16 v[28:31], v[172:175], v[68:71], v[28:31]
    ds_read_b64_tr_b16 v[110:111], v83 offset:2048
    s_add_u32 m0, s79, 147456
    s_add_u32 s64, s57, 2359296
    buffer_load_dwordx4 v92, s[20:23], s64 offen offset:0 lds
    v_mfma_f32_16x16x32_bf16 v[32:35], v[176:179], v[64:67], v[32:35]
    ds_read_b64_tr_b16 v[112:113], v84 offset:0
    v_mfma_f32_16x16x32_bf16 v[36:39], v[176:179], v[68:71], v[36:39]
    ds_read_b64_tr_b16 v[114:115], v84 offset:2048
    v_mfma_f32_16x16x32_bf16 v[40:43], v[180:183], v[64:67], v[40:43]
    ds_read_b64_tr_b16 v[116:117], v85 offset:0
    v_mfma_f32_16x16x32_bf16 v[44:47], v[180:183], v[68:71], v[44:47]
    ds_read_b64_tr_b16 v[118:119], v85 offset:2048
    buffer_load_dwordx4 v93, s[20:23], s64 offen offset:1024 lds
    v_mfma_f32_16x16x32_bf16 v[48:51], v[184:187], v[64:67], v[48:51]
    ds_read_b64_tr_b16 v[120:121], v86 offset:0
    s_waitcnt lgkmcnt(14)
    ds_read_b64_tr_b16 v[122:123], v86 offset:2048
    v_mfma_f32_16x16x32_bf16 v[52:55], v[184:187], v[68:71], v[52:55]
    s_waitcnt lgkmcnt(14)
    ds_read_b64_tr_b16 v[124:125], v87 offset:0
    s_waitcnt lgkmcnt(14)
    ds_read_b64_tr_b16 v[126:127], v87 offset:2048
    v_mfma_f32_16x16x32_bf16 v[56:59], v[188:191], v[64:67], v[56:59]
    v_mfma_f32_16x16x32_bf16 v[60:63], v[188:191], v[68:71], v[60:63]
    s_add_u32 m0, s79, 0
    s_add_u32 s64, s76, 0
    buffer_load_dwordx4 v95, s[8:11], s64 offen offset:1024 nt lds
    s_lshr_b32 s65, s33, 1
    s_cmp_lg_u32 s65, 1
    s_cbranch_scc1 L_st4
    s_mul_i32 s70, s33, 3
    s_add_u32 s70, s70, 0
    s_mul_i32 s71, s70, 205
    s_lshr_b32 s71, s71, 10
    s_mul_i32 s71, s71, 650240
    s_add_u32 s71, s71, s86
    s_lshl_b32 s65, s70, 10
    s_add_u32 s71, s71, s65
    s_cmp_lt_u32 s70, 20
    s_cselect_b32 s71, s71, 2130706432
    buffer_store_dwordx4 v[128:131], v202, s[28:31], s71 offen sc1
L_st4:
    s_waitcnt lgkmcnt(0)
    s_waitcnt vmcnt(10)
    s_barrier
    v_mfma_f32_16x16x32_bf16 v[0:3], v[96:99], v[72:75], v[0:3]
    ds_read_b128 v[64:67], v88 offset:32768
    ds_read_b64_tr_b16 v[160:161], v192 offset:0
    v_mfma_f32_16x16x32_bf16 v[4:7], v[96:99], v[76:79], v[4:7]
    ds_read_b64_tr_b16 v[162:163], v192 offset:2048
    v_mfma_f32_16x16x32_bf16 v[8:11], v[100:103], v[72:75], v[8:11]
    ds_read_b128 v[68:71], v88 offset:34816
    ds_read_b64_tr_b16 v[164:165], v193 offset:0
    v_mfma_f32_16x16x32_bf16 v[12:15], v[100:103], v[76:79], v[12:15]
    ds_read_b64_tr_b16 v[166:167], v193 offset:2048
    s_add_u32 m0, s79, 65536
    s_add_u32 s64, s56, 640
    buffer_load_dwordx4 v90, s[16:19], s64 offen offset:0 lds
    v_mfma_f32_16x16x32_bf16 v[16:19], v[104:107], v[72:75], v[16:19]
    ds_read_b64_tr_b16 v[168:169], v194 offset:0
    v_mfma_f32_16x16x32_bf16 v[20:23], v[104:107], v[76:79], v[20:23]
    ds_read_b64_tr_b16 v[170:171], v194 offset:2048
    v_mfma_f32_16x16x32_bf16 v[24:27], v[108:111], v[72:75], v[24:27]
    ds_read_b64_tr_b16 v[172:173], v195 offset:0
    v_mfma_f32_16x16x32_bf16 v[28:31], v[108:111], v[76:79], v[28:31]
    ds_read_b64_tr_b16 v[174:175], v195 offset:2048
    s_add_u32 m0, s79, 32768
    s_add_u32 s64, s57, 2621440
    buffer_load_dwordx4 v92, s[20:23], s64 offen offset:0 lds
    v_mfma_f32_16x16x32_bf16 v[32:35], v[112:115], v[72:75], v[32:35]
    ds_read_b64_tr_b16 v[176:177], v196 offset:0
    v_mfma_f32_16x16x32_bf16 v[36:39], v[112:115], v[76:79], v[36:39]
    ds_read_b64_tr_b16 v[178:179], v196 offset:2048
    v_mfma_f32_16x16x32_bf16 v[40:43], v[116:119], v[72:75], v[40:43]
    ds_read_b64_tr_b16 v[180:181], v197 offset:0
    v_mfma_f32_16x16x32_bf16 v[44:47], v[116:119], v[76:79], v[44:47]
    ds_read_b64_tr_b16 v[182:183], v197 offset:2048
    buffer_load_dwordx4 v93, s[20:23], s64 offen offset:1024 lds
    v_mfma_f32_16x16x32_bf16 v[48:51], v[120:123], v[72:75], v[48:51]
    ds_read_b64_tr_b16 v[184:185], v198 offset:0
    s_waitcnt lgkmcnt(14)
    ds_read_b64_tr_b16 v[186:187], v198 offset:2048
    v_mfma_f32_16x16x32_bf16 v[52:55], v[120:123], v[76:79], v[52:55]
    s_waitcnt lgkmcnt(14)
    ds_read_b64_tr_b16 v[188:189], v199 offset:0
    s_waitcnt lgkmcnt(14)
    ds_read_b64_tr_b16 v[190:191], v199 offset:2048
    v_mfma_f32_16x16x32_bf16 v[56:59], v[124:127], v[72:75], v[56:59]
    v_mfma_f32_16x16x32_bf16 v[60:63], v[124:127], v[76:79], v[60:63]
    s_add_u32 m0, s79, 16384
    s_add_u32 s64, s76, 0
    buffer_load_dwordx4 v220, s[12:15], s64 offen offset:0 nt lds
    s_lshr_b32 s65, s33, 1
    s_cmp_lg_u32 s65, 2
    s_cbranch_scc1 L_st5
    s_mul_i32 s70, s33, 3
    s_add_u32 s70, s70, 0
    s_mul_i32 s71, s70, 205
    s_lshr_b32 s71, s71, 10
    s_mul_i32 s71, s71, 650240
    s_add_u32 s71, s71, s86
    s_lshl_b32 s65, s70, 10
    s_add_u32 s71, s71, s65
    s_cmp_lt_u32 s70, 20
    s_cselect_b32 s71, s71, 2130706432
    buffer_store_dwordx4 v[128:131], v202, s[28:31], s71 offen sc1
L_st5:
    s_waitcnt lgkmcnt(0)
    s_waitcnt vmcnt(12)
    s_barrier
    v_mfma_f32_16x16x32_bf16 v[0:3], v[160:163], v[64:67], v[0:3]
    ds_read_b128 v[72:75], v89 offset:32768
    ds_read_b64_tr_b16 v[96:97], v192 offset:16384
    v_mfma_f32_16x16x32_bf16 v[4:7], v[160:163], v[68:71], v[4:7]
    ds_read_b64_tr_b16 v[98:99], v192 offset:18432
    v_mfma_f32_16x16x32_bf16 v[8:11], v[164:167], v[64:67], v[8:11]
    ds_read_b128 v[76:79], v89 offset:34816
    ds_read_b64_tr_b16 v[100:101], v193 offset:16384
    v_mfma_f32_16x16x32_bf16 v[12:15], v[164:167], v[68:71], v[12:15]
    ds_read_b64_tr_b16 v[102:103], v193 offset:18432
    s_add_u32 m0, s79, 65536
    s_add_u32 s64, s56, 640
    buffer_load_dwordx4 v91, s[16:19], s64 offen offset:1024 lds
    v_mfma_f32_16x16x32_bf16 v[16:19], v[168:171], v[64:67], v[16:19]
    ds_read_b64_tr_b16 v[104:105], v194 offset:16384
    v_mfma_f32_16x16x32_bf16 v[20:23], v[168:171], v[68:71], v[20:23]
    ds_read_b64_tr_b16 v[106:107], v194 offset:18432
    v_mfma_f32_16x16x32_bf16 v[24:27], v[172:175], v[64:67], v[24:27]
    ds_read_b64_tr_b16 v[108:109], v195 offset:16384
    v_mfma_f32_16x16x32_bf16 v[28:31], v[172:175], v[68:71], v[28:31]
    ds_read_b64_tr_b16 v[110:111], v195 offset:18432
    s_add_u32 m0, s79, 98304
    s_add_u32 s64, s57, 2883584
    buffer_load_dwordx4 v92, s[20:23], s64 offen offset:0 lds
    v_mfma_f32_16x16x32_bf16 v[32:35], v[176:179], v[64:67], v[32:35]
    ds_read_b64_tr_b16 v[112:113], v196 offset:16384
    v_mfma_f32_16x16x32_bf16 v[36:39], v[176:179], v[68:71], v[36:39]
    ds_read_b64_tr_b16 v[114:115], v196 offset:18432
    v_mfma_f32_16x16x32_bf16 v[40:43], v[180:183], v[64:67], v[40:43]
    ds_read_b64_tr_b16 v[116:117], v197 offset:16384
    v_mfma_f32_16x16x32_bf16 v[44:47], v[180:183], v[68:71], v[44:47]
    ds_read_b64_tr_b16 v[118:119], v197 offset:18432
    buffer_load_dwordx4 v93, s[20:23], s64 offen offset:1024 lds
    v_mfma_f32_16x16x32_bf16 v[48:51], v[184:187], v[64:67], v[48:51]
    ds_read_b64_tr_b16 v[120:121], v198 offset:16384
    s_waitcnt lgkmcnt(14)
    ds_read_b64_tr_b16 v[122:123], v198 offset:18432
    v_mfma_f32_16x16x32_bf16 v[52:55], v[184:187], v[68:71], v[52:55]
    s_waitcnt lgkmcnt(14)
    ds_read_b64_tr_b16 v[124:125], v199 offset:16384
    s_waitcnt lgkmcnt(14)
    ds_read_b64_tr_b16 v[126:127], v199 offset:18432
    v_mfma_f32_16x16x32_bf16 v[56:59], v[188:191], v[64:67], v[56:59]
    v_mfma_f32_16x16x32_bf16 v[60:63], v[188:191], v[68:71], v[60:63]
    s_add_u32 m0, s79, 16384
    s_add_u32 s64, s76, 0
    buffer_load_dwordx4 v221, s[12:15], s64 offen offset:1024 nt lds
    s_lshr_b32 s65, s33, 1
    s_cmp_lg_u32 s65, 3
    s_cbranch_scc1 L_st6
    s_mul_i32 s70, s33, 3
    s_add_u32 s70, s70, 0
    s_mul_i32 s71, s70, 205
    s_lshr_b32 s71, s71, 10
    s_mul_i32 s71, s71, 650240
    s_add_u32 s71, s71, s86
    s_lshl_b32 s65, s70, 10
    s_add_u32 s71, s71, s65
    s_cmp_lt_u32 s70, 20
    s_cselect_b32 s71, s71, 2130706432
    buffer_store_dwordx4 v[128:131], v202, s[28:31], s71 offen sc1
L_st6:
    s_waitcnt lgkmcnt(0)
    s_waitcnt vmcnt(11)
    s_barrier
    v_mfma_f32_16x16x32_bf16 v[0:3], v[96:99], v[72:75], v[0:3]
    ds_read_b128 v[64:67], v88 offset:0
    ds_read_b64_tr_b16 v[160:161], v192 offset:32768
    v_mfma_f32_16x16x32_bf16 v[4:7], v[96:99], v[76:79], v[4:7]
    ds_read_b64_tr_b16 v[162:163], v192 offset:34816
    v_mfma_f32_16x16x32_bf16 v[8:11], v[100:103], v[72:75], v[8:11]
    ds_read_b128 v[68:71], v88 offset:2048
    ds_read_b64_tr_b16 v[164:165], v193 offset:32768
    v_mfma_f32_16x16x32_bf16 v[12:15], v[100:103], v[76:79], v[12:15]
    ds_read_b64_tr_b16 v[166:167], v193 offset:34816
    v_mfma_f32_16x16x32_bf16 v[16:19], v[104:107], v[72:75], v[16:19]
    ds_read_b64_tr_b16 v[168:169], v194 offset:32768
    v_mfma_f32_16x16x32_bf16 v[20:23], v[104:107], v[76:79], v[20:23]
    ds_read_b64_tr_b16 v[170:171], v194 offset:34816
    s_add_u32 m0, s79, 81920
    s_add_u32 s64, s56, 768
    buffer_load_dwordx4 v90, s[16:19], s64 offen offset:0 lds
    v_mfma_f32_16x16x32_bf16 v[24:27], v[108:111], v[72:75], v[24:27]
    ds_read_b64_tr_b16 v[172:173], v195 offset:32768
    v_mfma_f32_16x16x32_bf16 v[28:31], v[108:111], v[76:79], v[28:31]
    ds_read_b64_tr_b16 v[174:175], v195 offset:34816
    v_mfma_f32_16x16x32_bf16 v[32:35], v[112:115], v[72:75], v[32:35]
    ds_read_b64_tr_b16 v[176:177], v196 offset:32768
    v_mfma_f32_16x16x32_bf16 v[36:39], v[112:115], v[76:79], v[36:39]
    ds_read_b64_tr_b16 v[178:179], v196 offset:34816
    v_mfma_f32_16x16x32_bf16 v[40:43], v[116:119], v[72:75], v[40:43]
    ds_read_b64_tr_b16 v[180:181], v197 offset:32768
    v_mfma_f32_16x16x32_bf16 v[44:47], v[116:119], v[76:79], v[44:47]
    ds_read_b64_tr_b16 v[182:183], v197 offset:34816
    s_add_u32 m0, s79, 114688
    s_add_u32 s64, s57, 3145728
    buffer_load_dwordx4 v92, s[20:23], s64 offen offset:0 lds
    v_mfma_f32_16x16x32_bf16 v[48:51], v[120:123], v[72:75], v[48:51]
    ds_read_b64_tr_b16 v[184:185], v198 offset:32768
    s_waitcnt lgkmcnt(14)
    ds_read_b64_tr_b16 v[186:187], v198 offset:34816
    v_mfma_f32_16x16x32_bf16 v[52:55], v[120:123], v[76:79], v[52:55]
    s_waitcnt lgkmcnt(14)
    ds_read_b64_tr_b16 v[188:189], v199 offset:32768
    s_waitcnt lgkmcnt(14)
    ds_read_b64_tr_b16 v[190:191], v199 offset:34816
    v_mfma_f32_16x16x32_bf16 v[56:59], v[124:127], v[72:75], v[56:59]
    v_mfma_f32_16x16x32_bf16 v[60:63], v[124:127], v[76:79], v[60:63]
    buffer_load_dwordx4 v93, s[20:23], s64 offen offset:1024 lds
    s_lshr_b32 s65, s33, 1
    s_cmp_lg_u32 s65, 0
    s_cbranch_scc1 L_st7
    s_mul_i32 s70, s33, 3
    s_add_u32 s70, s70, 1
    s_mul_i32 s71, s70, 205
    s_lshr_b32 s71, s71, 10
    s_mul_i32 s71, s71, 650240
    s_add_u32 s71, s71, s86
    s_lshl_b32 s65, s70, 10
    s_add_u32 s71, s71, s65
    s_cmp_lt_u32 s70, 20
    s_cselect_b32 s71, s71, 2130706432
    buffer_store_dwordx4 v[132:135], v202, s[28:31], s71 offen sc1
L_st7:
    s_waitcnt lgkmcnt(0)
    s_waitcnt vmcnt(12)
    s_barrier
    v_mfma_f32_16x16x32_bf16 v[0:3], v[160:163], v[64:67], v[0:3]
    ds_read_b128 v[72:75], v89 offset:0
    ds_read_b64_tr_b16 v[96:97], v192 offset:49152
    v_mfma_f32_16x16x32_bf16 v[4:7], v[160:163], v[68:71], v[4:7]
    ds_read_b64_tr_b16 v[98:99], v192 offset:51200
    v_mfma_f32_16x16x32_bf16 v[8:11], v[164:167], v[64:67], v[8:11]
    ds_read_b128 v[76:79], v89 offset:2048
    ds_read_b64_tr_b16 v[100:101], v193 offset:49152
    v_mfma_f32_16x16x32_bf16 v[12:15], v[164:167], v[68:71], v[12:15]
    ds_read_b64_tr_b16 v[102:103], v193 offset:51200
    v_mfma_f32_16x16x32_bf16 v[16:19], v[168:171], v[64:67], v[16:19]
    ds_read_b64_tr_b16 v[104:105], v194 offset:49152
    v_mfma_f32_16x16x32_bf16 v[20:23], v[168:171], v[68:71], v[20:23]
    ds_read_b64_tr_b16 v[106:107], v194 offset:51200
    s_add_u32 m0, s79, 81920
    s_add_u32 s64, s56, 768
    buffer_load_dwordx4 v91, s[16:19], s64 offen offset:1024 lds
    v_mfma_f32_16x16x32_bf16 v[24:27], v[172:175], v[64:67], v[24:27]
    ds_read_b64_tr_b16 v[108:109], v195 offset:49152
    v_mfma_f32_16x16x32_bf16 v[28:31], v[172:175], v[68:71], v[28:31]
    ds_read_b64_tr_b16 v[110:111], v195 offset:51200
    v_mfma_f32_16x16x32_bf16 v[32:35], v[176:179], v[64:67], v[32:35]
    ds_read_b64_tr_b16 v[112:113], v196 offset:49152
    v_mfma_f32_16x16x32_bf16 v[36:39], v[176:179], v[68:71], v[36:39]
    ds_read_b64_tr_b16 v[114:115], v196 offset:51200
    v_mfma_f32_16x16x32_bf16 v[40:43], v[180:183], v[64:67], v[40:43]
    ds_read_b64_tr_b16 v[116:117], v197 offset:49152
    v_mfma_f32_16x16x32_bf16 v[44:47], v[180:183], v[68:71], v[44:47]
    ds_read_b64_tr_b16 v[118:119], v197 offset:51200
    s_add_u32 m0, s79, 131072
    s_add_u32 s64, s57, 3407872
    buffer_load_dwordx4 v92, s[20:23], s64 offen offset:0 lds
    v_mfma_f32_16x16x32_bf16 v[48:51], v[184:187], v[64:67], v[48:51]
    ds_read_b64_tr_b16 v[120:121], v198 offset:49152
    s_waitcnt lgkmcnt(14)
    ds_read_b64_tr_b16 v[122:123], v198 offset:51200
    v_mfma_f32_16x16x32_bf16 v[52:55], v[184:187], v[68:71], v[52:55]
    s_waitcnt lgkmcnt(14)
    ds_read_b64_tr_b16 v[124:125], v199 offset:49152
    s_waitcnt lgkmcnt(14)
    ds_read_b64_tr_b16 v[126:127], v199 offset:51200
    v_mfma_f32_16x16x32_bf16 v[56:59], v[188:191], v[64:67], v[56:59]
    v_mfma_f32_16x16x32_bf16 v[60:63], v[188:191], v[68:71], v[60:63]
    buffer_load_dwordx4 v93, s[20:23], s64 offen offset:1024 lds
    s_lshr_b32 s65, s33, 1
    s_cmp_lg_u32 s65, 1
    s_cbranch_scc1 L_st8
    s_mul_i32 s70, s33, 3
    s_add_u32 s70, s70, 1
    s_mul_i32 s71, s70, 205
    s_lshr_b32 s71, s71, 10
    s_mul_i32 s71, s71, 650240
    s_add_u32 s71, s71, s86
    s_lshl_b32 s65, s70, 10
    s_add_u32 s71, s71, s65
    s_cmp_lt_u32 s70, 20
    s_cselect_b32 s71, s71, 2130706432
    buffer_store_dwordx4 v[132:135], v202, s[28:31], s71 offen sc1
L_st8:
    s_waitcnt lgkmcnt(0)
    s_waitcnt vmcnt(9)
    s_barrier
    v_mfma_f32_16x16x32_bf16 v[0:3], v[96:99], v[72:75], v[0:3]
    ds_read_b128 v[64:67], v88 offset:16384
    ds_read_b64_tr_b16 v[160:161], v80 offset:0
    v_mfma_f32_16x16x32_bf16 v[4:7], v[96:99], v[76:79], v[4:7]
    ds_read_b64_tr_b16 v[162:163], v80 offset:2048
    v_mfma_f32_16x16x32_bf16 v[8:11], v[100:103], v[72:75], v[8:11]
    ds_read_b128 v[68:71], v88 offset:18432
    ds_read_b64_tr_b16 v[164:165], v81 offset:0
    v_mfma_f32_16x16x32_bf16 v[12:15], v[100:103], v[76:79], v[12:15]
    ds_read_b64_tr_b16 v[166:167], v81 offset:2048
    v_mfma_f32_16x16x32_bf16 v[16:19], v[104:107], v[72:75], v[16:19]
    ds_read_b64_tr_b16 v[168:169], v82 offset:0
    v_mfma_f32_16x16x32_bf16 v[20:23], v[104:107], v[76:79], v[20:23]
    ds_read_b64_tr_b16 v[170:171], v82 offset:2048
    s_add_u32 m0, s79, 49152
    s_add_u32 s64, s56, 896
    buffer_load_dwordx4 v90, s[16:19], s64 offen offset:0 lds
    v_mfma_f32_16x16x32_bf16 v[24:27], v[108:111], v[72:75], v[24:27]
    ds_read_b64_tr_b16 v[172:173], v83 offset:0
    v_mfma_f32_16x16x32_bf16 v[28:31], v[108:111], v[76:79], v[28:31]
    ds_read_b64_tr_b16 v[174:175], v83 offset:2048
    v_mfma_f32_16x16x32_bf16 v[32:35], v[112:115], v[72:75], v[32:35]
    ds_read_b64_tr_b16 v[176:177], v84 offset:0
    v_mfma_f32_16x16x32_bf16 v[36:39], v[112:115], v[76:79], v[36:39]
    ds_read_b64_tr_b16 v[178:179], v84 offset:2048
    v_mfma_f32_16x16x32_bf16 v[40:43], v[116:119], v[72:75], v[40:43]
    ds_read_b64_tr_b16 v[180:181], v85 offset:0
    v_mfma_f32_16x16x32_bf16 v[44:47], v[116:119], v[76:79], v[44:47]
    ds_read_b64_tr_b16 v[182:183], v85 offset:2048
    s_add_u32 m0, s79, 147456
    s_add_u32 s64, s57, 3670016
    buffer_load_dwordx4 v92, s[20:23], s64 offen offset:0 lds
    v_mfma_f32_16x16x32_bf16 v[48:51], v[120:123], v[72:75], v[48:51]
    ds_read_b64_tr_b16 v[184:185], v86 offset:0
    s_waitcnt lgkmcnt(14)
    ds_read_b64_tr_b16 v[186:187], v86 offset:2048
    v_mfma_f32_16x16x32_bf16 v[52:55], v[120:123], v[76:79], v[52:55]
    s_waitcnt lgkmcnt(14)
    ds_read_b64_tr_b16 v[188:189], v87 offset:0
    s_waitcnt lgkmcnt(14)
    ds_read_b64_tr_b16 v[190:191], v87 offset:2048
    v_mfma_f32_16x16x32_bf16 v[56:59], v[124:127], v[72:75], v[56:59]
    v_mfma_f32_16x16x32_bf16 v[60:63], v[124:127], v[76:79], v[60:63]
    buffer_load_dwordx4 v93, s[20:23], s64 offen offset:1024 lds
    s_lshr_b32 s65, s33, 1
    s_cmp_lg_u32 s65, 2
    s_cbranch_scc1 L_st9
    s_mul_i32 s70, s33, 3
    s_add_u32 s70, s70, 1
    s_mul_i32 s71, s70, 205
    s_lshr_b32 s71, s71, 10
    s_mul_i32 s71, s71, 650240
    s_add_u32 s71, s71, s86
    s_lshl_b32 s65, s70, 10
    s_add_u32 s71, s71, s65
    s_cmp_lt_u32 s70, 20
    s_cselect_b32 s71, s71, 2130706432
    buffer_store_dwordx4 v[132:135], v202, s[28:31], s71 offen sc1
L_st9:
    s_waitcnt lgkmcnt(0)
    s_waitcnt vmcnt(10)
    s_barrier
    v_mfma_f32_16x16x32_bf16 v[0:3], v[160:163], v[64:67], v[0:3]
    ds_read_b128 v[72:75], v89 offset:16384
    ds_read_b64_tr_b16 v[96:97], v192 offset:0
    v_mfma_f32_16x16x32_bf16 v[4:7], v[160:163], v[68:71], v[4:7]
    ds_read_b64_tr_b16 v[98:99], v192 offset:2048
    v_mfma_f32_16x16x32_bf16 v[8:11], v[164:167], v[64:67], v[8:11]
    ds_read_b128 v[76:79], v89 offset:18432
    ds_read_b64_tr_b16 v[100:101], v193 offset:0
    v_mfma_f32_16x16x32_bf16 v[12:15], v[164:167], v[68:71], v[12:15]
    ds_read_b64_tr_b16 v[102:103], v193 offset:2048
    v_mfma_f32_16x16x32_bf16 v[16:19], v[168:171], v[64:67], v[16:19]
    ds_read_b64_tr_b16 v[104:105], v194 offset:0
    v_mfma_f32_16x16x32_bf16 v[20:23], v[168:171], v[68:71], v[20:23]
    ds_read_b64_tr_b16 v[106:107], v194 offset:2048
    s_add_u32 m0, s79, 49152
    s_add_u32 s64, s56, 896
    buffer_load_dwordx4 v91, s[16:19], s64 offen offset:1024 lds
    v_mfma_f32_16x16x32_bf16 v[24:27], v[172:175], v[64:67], v[24:27]
    ds_read_b64_tr_b16 v[108:109], v195 offset:0
    v_mfma_f32_16x16x32_bf16 v[28:31], v[172:175], v[68:71], v[28:31]
    ds_read_b64_tr_b16 v[110:111], v195 offset:2048
    v_mfma_f32_16x16x32_bf16 v[32:35], v[176:179], v[64:67], v[32:35]
    ds_read_b64_tr_b16 v[112:113], v196 offset:0
    v_mfma_f32_16x16x32_bf16 v[36:39], v[176:179], v[68:71], v[36:39]
    ds_read_b64_tr_b16 v[114:115], v196 offset:2048
    v_mfma_f32_16x16x32_bf16 v[40:43], v[180:183], v[64:67], v[40:43]
    ds_read_b64_tr_b16 v[116:117], v197 offset:0
    v_mfma_f32_16x16x32_bf16 v[44:47], v[180:183], v[68:71], v[44:47]
    ds_read_b64_tr_b16 v[118:119], v197 offset:2048
    s_add_u32 m0, s79, 32768
    s_add_u32 s64, s57, 3932160
    buffer_load_dwordx4 v92, s[20:23], s64 offen offset:0 lds
    v_mfma_f32_16x16x32_bf16 v[48:51], v[184:187], v[64:67], v[48:51]
    ds_read_b64_tr_b16 v[120:121], v198 offset:0
    s_waitcnt lgkmcnt(14)
    ds_read_b64_tr_b16 v[122:123], v198 offset:2048
    v_mfma_f32_16x16x32_bf16 v[52:55], v[184:187], v[68:71], v[52:55]
    s_waitcnt lgkmcnt(14)
    ds_read_b64_tr_b16 v[124:125], v199 offset:0
    s_waitcnt lgkmcnt(14)
    ds_read_b64_tr_b16 v[126:127], v199 offset:2048
    v_mfma_f32_16x16x32_bf16 v[56:59], v[188:191], v[64:67], v[56:59]
    v_mfma_f32_16x16x32_bf16 v[60:63], v[188:191], v[68:71], v[60:63]
    buffer_load_dwordx4 v93, s[20:23], s64 offen offset:1024 lds
    s_lshr_b32 s65, s33, 1
    s_cmp_lg_u32 s65, 3
    s_cbranch_scc1 L_st10
    s_mul_i32 s70, s33, 3
    s_add_u32 s70, s70, 1
    s_mul_i32 s71, s70, 205
    s_lshr_b32 s71, s71, 10
    s_mul_i32 s71, s71, 650240
    s_add_u32 s71, s71, s86
    s_lshl_b32 s65, s70, 10
    s_add_u32 s71, s71, s65
    s_cmp_lt_u32 s70, 20
    s_cselect_b32 s71, s71, 2130706432
    buffer_store_dwordx4 v[132:135], v202, s[28:31], s71 offen sc1
L_st10:
    s_waitcnt lgkmcnt(0)
    s_waitcnt vmcnt(8)
    s_barrier
    v_mfma_f32_16x16x32_bf16 v[0:3], v[96:99], v[72:75], v[0:3]
    ds_read_b128 v[64:67], v88 offset:32768
    ds_read_b64_tr_b16 v[160:161], v192 offset:16384
    v_mfma_f32_16x16x32_bf16 v[4:7], v[96:99], v[76:79], v[4:7]
    ds_read_b64_tr_b16 v[162:163], v192 offset:18432
    v_mfma_f32_16x16x32_bf16 v[8:11], v[100:103], v[72:75], v[8:11]
    ds_read_b128 v[68:71], v88 offset:34816
    ds_read_b64_tr_b16 v[164:165], v193 offset:16384
    v_mfma_f32_16x16x32_bf16 v[12:15], v[100:103], v[76:79], v[12:15]
    ds_read_b64_tr_b16 v[166:167], v193 offset:18432
    v_mfma_f32_16x16x32_bf16 v[16:19], v[104:107], v[72:75], v[16:19]
    ds_read_b64_tr_b16 v[168:169], v194 offset:16384
    v_mfma_f32_16x16x32_bf16 v[20:23], v[104:107], v[76:79], v[20:23]
    ds_read_b64_tr_b16 v[170:171], v194 offset:18432
    s_add_u32 m0, s79, 65536
    s_add_u32 s64, s56, 1024
    buffer_load_dwordx4 v90, s[16:19], s64 offen offset:0 lds
    v_mfma_f32_16x16x32_bf16 v[24:27], v[108:111], v[72:75], v[24:27]
    ds_read_b64_tr_b16 v[172:173], v195 offset:16384
    v_mfma_f32_16x16x32_bf16 v[28:31], v[108:111], v[76:79], v[28:31]
    ds_read_b64_tr_b16 v[174:175], v195 offset:18432
    v_mfma_f32_16x16x32_bf16 v[32:35], v[112:115], v[72:75], v[32:35]
    ds_read_b64_tr_b16 v[176:177], v196 offset:16384
    v_mfma_f32_16x16x32_bf16 v[36:39], v[112:115], v[76:79], v[36:39]
    ds_read_b64_tr_b16 v[178:179], v196 offset:18432
    v_mfma_f32_16x16x32_bf16 v[40:43], v[116:119], v[72:75], v[40:43]
    ds_read_b64_tr_b16 v[180:181], v197 offset:16384
    v_mfma_f32_16x16x32_bf16 v[44:47], v[116:119], v[76:79], v[44:47]
    ds_read_b64_tr_b16 v[182:183], v197 offset:18432
    s_add_u32 m0, s79, 98304
    s_add_u32 s64, s57, 4194304
    buffer_load_dwordx4 v92, s[20:23], s64 offen offset:0 lds
    v_mfma_f32_16x16x32_bf16 v[48:51], v[120:123], v[72:75], v[48:51]
    ds_read_b64_tr_b16 v[184:185], v198 offset:16384
    s_waitcnt lgkmcnt(14)
    ds_read_b64_tr_b16 v[186:187], v198 offset:18432
    v_mfma_f32_16x16x32_bf16 v[52:55], v[120:123], v[76:79], v[52:55]
    s_waitcnt lgkmcnt(14)
    ds_read_b64_tr_b16 v[188:189], v199 offset:16384
    s_waitcnt lgkmcnt(14)
    ds_read_b64_tr_b16 v[190:191], v199 offset:18432
    v_mfma_f32_16x16x32_bf16 v[56:59], v[124:127], v[72:75], v[56:59]
    v_mfma_f32_16x16x32_bf16 v[60:63], v[124:127], v[76:79], v[60:63]
    buffer_load_dwordx4 v93, s[20:23], s64 offen offset:1024 lds
    s_lshr_b32 s65, s33, 1
    s_cmp_lg_u32 s65, 0
    s_cbranch_scc1 L_st11
    s_mul_i32 s70, s33, 3
    s_add_u32 s70, s70, 2
    s_mul_i32 s71, s70, 205
    s_lshr_b32 s71, s71, 10
    s_mul_i32 s71, s71, 650240
    s_add_u32 s71, s71, s86
    s_lshl_b32 s65, s70, 10
    s_add_u32 s71, s71, s65
    s_cmp_lt_u32 s70, 20
    s_cselect_b32 s71, s71, 2130706432
    buffer_store_dwordx4 v[136:139], v202, s[28:31], s71 offen sc1
L_st11:
    s_waitcnt lgkmcnt(0)
    s_waitcnt vmcnt(9)
    s_barrier
    v_mfma_f32_16x16x32_bf16 v[0:3], v[160:163], v[64:67], v[0:3]
    ds_read_b128 v[72:75], v89 offset:32768
    ds_read_b64_tr_b16 v[96:97], v192 offset:32768
    v_mfma_f32_16x16x32_bf16 v[4:7], v[160:163], v[68:71], v[4:7]
    ds_read_b64_tr_b16 v[98:99], v192 offset:34816
    v_mfma_f32_16x16x32_bf16 v[8:11], v[164:167], v[64:67], v[8:11]
    ds_read_b128 v[76:79], v89 offset:34816
    ds_read_b64_tr_b16 v[100:101], v193 offset:32768
    v_mfma_f32_16x16x32_bf16 v[12:15], v[164:167], v[68:71], v[12:15]
    ds_read_b64_tr_b16 v[102:103], v193 offset:34816
    v_mfma_f32_16x16x32_bf16 v[16:19], v[168:171], v[64:67], v[16:19]
    ds_read_b64_tr_b16 v[104:105], v194 offset:32768
    v_mfma_f32_16x16x32_bf16 v[20:23], v[168:171], v[68:71], v[20:23]
    ds_read_b64_tr_b16 v[106:107], v194 offset:34816
    s_add_u32 m0, s79, 65536
    s_add_u32 s64, s56, 1024
    buffer_load_dwordx4 v91, s[16:19], s64 offen offset:1024 lds
    v_mfma_f32_16x16x32_bf16 v[24:27], v[172:175], v[64:67], v[24:27]
    ds_read_b64_tr_b16 v[108:109], v195 offset:32768
    v_mfma_f32_16x16x32_bf16 v[28:31], v[172:175], v[68:71], v[28:31]
    ds_read_b64_tr_b16 v[110:111], v195 offset:34816
    v_mfma_f32_16x16x32_bf16 v[32:35], v[176:179], v[64:67], v[32:35]
    ds_read_b64_tr_b16 v[112:113], v196 offset:32768
    v_mfma_f32_16x16x32_bf16 v[36:39], v[176:179], v[68:71], v[36:39]
    ds_read_b64_tr_b16 v[114:115], v196 offset:34816
    v_mfma_f32_16x16x32_bf16 v[40:43], v[180:183], v[64:67], v[40:43]
    ds_read_b64_tr_b16 v[116:117], v197 offset:32768
    v_mfma_f32_16x16x32_bf16 v[44:47], v[180:183], v[68:71], v[44:47]
    ds_read_b64_tr_b16 v[118:119], v197 offset:34816
    s_add_u32 m0, s79, 114688
    s_add_u32 s64, s57, 4456448
    buffer_load_dwordx4 v92, s[20:23], s64 offen offset:0 lds
    v_mfma_f32_16x16x32_bf16 v[48:51], v[184:187], v[64:67], v[48:51]
    ds_read_b64_tr_b16 v[120:121], v198 offset:32768
    s_waitcnt lgkmcnt(14)
    ds_read_b64_tr_b16 v[122:123], v198 offset:34816
    v_mfma_f32_16x16x32_bf16 v[52:55], v[184:187], v[68:71], v[52:55]
    s_waitcnt lgkmcnt(14)
    ds_read_b64_tr_b16 v[124:125], v199 offset:32768
    s_waitcnt lgkmcnt(14)
    ds_read_b64_tr_b16 v[126:127], v199 offset:34816
    v_mfma_f32_16x16x32_bf16 v[56:59], v[188:191], v[64:67], v[56:59]
    v_mfma_f32_16x16x32_bf16 v[60:63], v[188:191], v[68:71], v[60:63]
    buffer_load_dwordx4 v93, s[20:23], s64 offen offset:1024 lds
    s_lshr_b32 s65, s33, 1
    s_cmp_lg_u32 s65, 1
    s_cbranch_scc1 L_st12
    s_mul_i32 s70, s33, 3
    s_add_u32 s70, s70, 2
    s_mul_i32 s71, s70, 205
    s_lshr_b32 s71, s71, 10
    s_mul_i32 s71, s71, 650240
    s_add_u32 s71, s71, s86
    s_lshl_b32 s65, s70, 10
    s_add_u32 s71, s71, s65
    s_cmp_lt_u32 s70, 20
    s_cselect_b32 s71, s71, 2130706432
    buffer_store_dwordx4 v[136:139], v202, s[28:31], s71 offen sc1
L_st12:
    s_waitcnt lgkmcnt(0)
    s_waitcnt vmcnt(8)
    s_barrier
    v_mfma_f32_16x16x32_bf16 v[0:3], v[96:99], v[72:75], v[0:3]
    ds_read_b128 v[64:67], v88 offset:0
    ds_read_b64_tr_b16 v[160:161], v192 offset:49152
    v_mfma_f32_16x16x32_bf16 v[4:7], v[96:99], v[76:79], v[4:7]
    ds_read_b64_tr_b16 v[162:163], v192 offset:51200
    v_mfma_f32_16x16x32_bf16 v[8:11], v[100:103], v[72:75], v[8:11]
    ds_read_b128 v[68:71], v88 offset:2048
    ds_read_b64_tr_b16 v[164:165], v193 offset:49152
    v_mfma_f32_16x16x32_bf16 v[12:15], v[100:103], v[76:79], v[12:15]
    ds_read_b64_tr_b16 v[166:167], v193 offset:51200
    v_mfma_f32_16x16x32_bf16 v[16:19], v[104:107], v[72:75], v[16:19]
    ds_read_b64_tr_b16 v[168:169], v194 offset:49152
    v_mfma_f32_16x16x32_bf16 v[20:23], v[104:107], v[76:79], v[20:23]
    ds_read_b64_tr_b16 v[170:171], v194 offset:51200
    s_add_u32 m0, s79, 81920
    s_add_u32 s64, s56, 1152
    buffer_load_dwordx4 v90, s[16:19], s64 offen offset:0 lds
    v_mfma_f32_16x16x32_bf16 v[24:27], v[108:111], v[72:75], v[24:27]
    ds_read_b64_tr_b16 v[172:173], v195 offset:49152
    v_mfma_f32_16x16x32_bf16 v[28:31], v[108:111], v[76:79], v[28:31]
    ds_read_b64_tr_b16 v[174:175], v195 offset:51200
    v_mfma_f32_16x16x32_bf16 v[32:35], v[112:115], v[72:75], v[32:35]
    ds_read_b64_tr_b16 v[176:177], v196 offset:49152
    v_mfma_f32_16x16x32_bf16 v[36:39], v[112:115], v[76:79], v[36:39]
    ds_read_b64_tr_b16 v[178:179], v196 offset:51200
    v_mfma_f32_16x16x32_bf16 v[40:43], v[116:119], v[72:75], v[40:43]
    ds_read_b64_tr_b16 v[180:181], v197 offset:49152
    v_mfma_f32_16x16x32_bf16 v[44:47], v[116:119], v[76:79], v[44:47]
    ds_read_b64_tr_b16 v[182:183], v197 offset:51200
    s_add_u32 m0, s79, 131072
    s_add_u32 s64, s57, 4718592
    buffer_load_dwordx4 v92, s[20:23], s64 offen offset:0 lds
    v_mfma_f32_16x16x32_bf16 v[48:51], v[120:123], v[72:75], v[48:51]
    ds_read_b64_tr_b16 v[184:185], v198 offset:49152
    s_waitcnt lgkmcnt(14)
    ds_read_b64_tr_b16 v[186:187], v198 offset:51200
    v_mfma_f32_16x16x32_bf16 v[52:55], v[120:123], v[76:79], v[52:55]
    s_waitcnt lgkmcnt(14)
    ds_read_b64_tr_b16 v[188:189], v199 offset:49152
    s_waitcnt lgkmcnt(14)
    ds_read_b64_tr_b16 v[190:191], v199 offset:51200
    v_mfma_f32_16x16x32_bf16 v[56:59], v[124:127], v[72:75], v[56:59]
    v_mfma_f32_16x16x32_bf16 v[60:63], v[124:127], v[76:79], v[60:63]
    buffer_load_dwordx4 v93, s[20:23], s64 offen offset:1024 lds
    s_lshr_b32 s65, s33, 1
    s_cmp_lg_u32 s65, 2
    s_cbranch_scc1 L_st13
    s_mul_i32 s70, s33, 3
    s_add_u32 s70, s70, 2
    s_mul_i32 s71, s70, 205
    s_lshr_b32 s71, s71, 10
    s_mul_i32 s71, s71, 650240
    s_add_u32 s71, s71, s86
    s_lshl_b32 s65, s70, 10
    s_add_u32 s71, s71, s65
    s_cmp_lt_u32 s70, 20
    s_cselect_b32 s71, s71, 2130706432
    buffer_store_dwordx4 v[136:139], v202, s[28:31], s71 offen sc1
L_st13:
    s_waitcnt lgkmcnt(0)
    s_waitcnt vmcnt(9)
    s_barrier
    v_mfma_f32_16x16x32_bf16 v[0:3], v[160:163], v[64:67], v[0:3]
    ds_read_b128 v[72:75], v89 offset:0
    ds_read_b64_tr_b16 v[96:97], v80 offset:0
    v_mfma_f32_16x16x32_bf16 v[4:7], v[160:163], v[68:71], v[4:7]
    ds_read_b64_tr_b16 v[98:99], v80 offset:2048
    v_mfma_f32_16x16x32_bf16 v[8:11], v[164:167], v[64:67], v[8:11]
    ds_read_b128 v[76:79], v89 offset:2048
    ds_read_b64_tr_b16 v[100:101], v81 offset:0
    v_mfma_f32_16x16x32_bf16 v[12:15], v[164:167], v[68:71], v[12:15]
    ds_read_b64_tr_b16 v[102:103], v81 offset:2048
    v_mfma_f32_16x16x32_bf16 v[16:19], v[168:171], v[64:67], v[16:19]
    ds_read_b64_tr_b16 v[104:105], v82 offset:0
    v_mfma_f32_16x16x32_bf16 v[20:23], v[168:171], v[68:71], v[20:23]
    ds_read_b64_tr_b16 v[106:107], v82 offset:2048
    s_add_u32 m0, s79, 81920
    s_add_u32 s64, s56, 1152
    buffer_load_dwordx4 v91, s[16:19], s64 offen offset:1024 lds
    v_mfma_f32_16x16x32_bf16 v[24:27], v[172:175], v[64:67], v[24:27]
    ds_read_b64_tr_b16 v[108:109], v83 offset:0
    v_mfma_f32_16x16x32_bf16 v[28:31], v[172:175], v[68:71], v[28:31]
    ds_read_b64_tr_b16 v[110:111], v83 offset:2048
    v_mfma_f32_16x16x32_bf16 v[32:35], v[176:179], v[64:67], v[32:35]
    ds_read_b64_tr_b16 v[112:113], v84 offset:0
    v_mfma_f32_16x16x32_bf16 v[36:39], v[176:179], v[68:71], v[36:39]
    ds_read_b64_tr_b16 v[114:115], v84 offset:2048
    v_mfma_f32_16x16x32_bf16 v[40:43], v[180:183], v[64:67], v[40:43]
    ds_read_b64_tr_b16 v[116:117], v85 offset:0
    v_mfma_f32_16x16x32_bf16 v[44:47], v[180:183], v[68:71], v[44:47]
    ds_read_b64_tr_b16 v[118:119], v85 offset:2048
    s_add_u32 m0, s79, 147456
    s_add_u32 s64, s57, 4980736
    buffer_load_dwordx4 v92, s[20:23], s64 offen offset:0 lds
    v_mfma_f32_16x16x32_bf16 v[48:51], v[184:187], v[64:67], v[48:51]
    ds_read_b64_tr_b16 v[120:121], v86 offset:0
    s_waitcnt lgkmcnt(14)
    ds_read_b64_tr_b16 v[122:123], v86 offset:2048
    v_mfma_f32_16x16x32_bf16 v[52:55], v[184:187], v[68:71], v[52:55]
    s_waitcnt lgkmcnt(14)
    ds_read_b64_tr_b16 v[124:125], v87 offset:0
    s_waitcnt lgkmcnt(14)
    ds_read_b64_tr_b16 v[126:127], v87 offset:2048
    v_mfma_f32_16x16x32_bf16 v[56:59], v[188:191], v[64:67], v[56:59]
    v_mfma_f32_16x16x32_bf16 v[60:63], v[188:191], v[68:71], v[60:63]
    buffer_load_dwordx4 v93, s[20:23], s64 offen offset:1024 lds
    s_lshr_b32 s65, s33, 1
    s_cmp_lg_u32 s65, 3
    s_cbranch_scc1 L_st14
    s_mul_i32 s70, s33, 3
    s_add_u32 s70, s70, 2
    s_mul_i32 s71, s70, 205
    s_lshr_b32 s71, s71, 10
    s_mul_i32 s71, s71, 650240
    s_add_u32 s71, s71, s86
    s_lshl_b32 s65, s70, 10
    s_add_u32 s71, s71, s65
    s_cmp_lt_u32 s70, 20
    s_cselect_b32 s71, s71, 2130706432
    buffer_store_dwordx4 v[136:139], v202, s[28:31], s71 offen sc1
L_st14:
    s_waitcnt lgkmcnt(0)
    s_waitcnt vmcnt(8)
    s_barrier
    v_mfma_f32_16x16x32_bf16 v[0:3], v[96:99], v[72:75], v[0:3]
    ds_read_b128 v[64:67], v88 offset:16384
    ds_read_b64_tr_b16 v[160:161], v192 offset:0
    v_mfma_f32_16x16x32_bf16 v[4:7], v[96:99], v[76:79], v[4:7]
    ds_read_b64_tr_b16 v[162:163], v192 offset:2048
    v_mfma_f32_16x16x32_bf16 v[8:11], v[100:103], v[72:75], v[8:11]
    ds_read_b128 v[68:71], v88 offset:18432
    ds_read_b64_tr_b16 v[164:165], v193 offset:0
    v_mfma_f32_16x16x32_bf16 v[12:15], v[100:103], v[76:79], v[12:15]
    ds_read_b64_tr_b16 v[166:167], v193 offset:2048
    v_mfma_f32_16x16x32_bf16 v[16:19], v[104:107], v[72:75], v[16:19]
    ds_read_b64_tr_b16 v[168:169], v194 offset:0
    v_mfma_f32_16x16x32_bf16 v[20:23], v[104:107], v[76:79], v[20:23]
    ds_read_b64_tr_b16 v[170:171], v194 offset:2048
    v_mfma_f32_16x16x32_bf16 v[24:27], v[108:111], v[72:75], v[24:27]
    ds_read_b64_tr_b16 v[172:173], v195 offset:0
    v_mfma_f32_16x16x32_bf16 v[28:31], v[108:111], v[76:79], v[28:31]
    ds_read_b64_tr_b16 v[174:175], v195 offset:2048
    s_add_u32 m0, s79, 32768
    s_add_u32 s64, s76, 16384
    buffer_load_dwordx4 v94, s[8:11], s64 offen offset:0 nt lds
    v_mfma_f32_16x16x32_bf16 v[32:35], v[112:115], v[72:75], v[32:35]
    ds_read_b64_tr_b16 v[176:177], v196 offset:0
    v_mfma_f32_16x16x32_bf16 v[36:39], v[112:115], v[76:79], v[36:39]
    ds_read_b64_tr_b16 v[178:179], v196 offset:2048
    v_mfma_f32_16x16x32_bf16 v[40:43], v[116:119], v[72:75], v[40:43]
    ds_read_b64_tr_b16 v[180:181], v197 offset:0
    v_mfma_f32_16x16x32_bf16 v[44:47], v[116:119], v[76:79], v[44:47]
    ds_read_b64_tr_b16 v[182:183], v197 offset:2048
    v_mfma_f32_16x16x32_bf16 v[48:51], v[120:123], v[72:75], v[48:51]
    ds_read_b64_tr_b16 v[184:185], v198 offset:0
    s_waitcnt lgkmcnt(14)
    ds_read_b64_tr_b16 v[186:187], v198 offset:2048
    v_mfma_f32_16x16x32_bf16 v[52:55], v[120:123], v[76:79], v[52:55]
    s_waitcnt lgkmcnt(14)
    ds_read_b64_tr_b16 v[188:189], v199 offset:0
    s_waitcnt lgkmcnt(14)
    ds_read_b64_tr_b16 v[190:191], v199 offset:2048
    v_mfma_f32_16x16x32_bf16 v[56:59], v[124:127], v[72:75], v[56:59]
    v_mfma_f32_16x16x32_bf16 v[60:63], v[124:127], v[76:79], v[60:63]
    buffer_load_dwordx4 v95, s[8:11], s64 offen offset:1024 nt lds
    s_waitcnt lgkmcnt(0)
    s_waitcnt vmcnt(8)
    s_barrier
    v_mfma_f32_16x16x32_bf16 v[0:3], v[160:163], v[64:67], v[0:3]
    ds_read_b128 v[72:75], v89 offset:16384
    ds_read_b64_tr_b16 v[96:97], v192 offset:16384
    v_mfma_f32_16x16x32_bf16 v[4:7], v[160:163], v[68:71], v[4:7]
    ds_read_b64_tr_b16 v[98:99], v192 offset:18432
    v_mfma_f32_16x16x32_bf16 v[8:11], v[164:167], v[64:67], v[8:11]
    ds_read_b128 v[76:79], v89 offset:18432
    ds_read_b64_tr_b16 v[100:101], v193 offset:16384
    v_mfma_f32_16x16x32_bf16 v[12:15], v[164:167], v[68:71], v[12:15]
    ds_read_b64_tr_b16 v[102:103], v193 offset:18432
    v_mfma_f32_16x16x32_bf16 v[16:19], v[168:171], v[64:67], v[16:19]
    ds_read_b64_tr_b16 v[104:105], v194 offset:16384
    v_mfma_f32_16x16x32_bf16 v[20:23], v[168:171], v[68:71], v[20:23]
    ds_read_b64_tr_b16 v[106:107], v194 offset:18432
    v_mfma_f32_16x16x32_bf16 v[24:27], v[172:175], v[64:67], v[24:27]
    ds_read_b64_tr_b16 v[108:109], v195 offset:16384
    v_mfma_f32_16x16x32_bf16 v[28:31], v[172:175], v[68:71], v[28:31]
    ds_read_b64_tr_b16 v[110:111], v195 offset:18432
    s_add_u32 m0, s79, 49152
    s_add_u32 s64, s76, 16384
    buffer_load_dwordx4 v220, s[12:15], s64 offen offset:0 nt lds
    v_mfma_f32_16x16x32_bf16 v[32:35], v[176:179], v[64:67], v[32:35]
    ds_read_b64_tr_b16 v[112:113], v196 offset:16384
    v_mfma_f32_16x16x32_bf16 v[36:39], v[176:179], v[68:71], v[36:39]
    ds_read_b64_tr_b16 v[114:115], v196 offset:18432
    v_mfma_f32_16x16x32_bf16 v[40:43], v[180:183], v[64:67], v[40:43]
    ds_read_b64_tr_b16 v[116:117], v197 offset:16384
    v_mfma_f32_16x16x32_bf16 v[44:47], v[180:183], v[68:71], v[44:47]
    ds_read_b64_tr_b16 v[118:119], v197 offset:18432
    v_mfma_f32_16x16x32_bf16 v[48:51], v[184:187], v[64:67], v[48:51]
    ds_read_b64_tr_b16 v[120:121], v198 offset:16384
    s_waitcnt lgkmcnt(14)
    ds_read_b64_tr_b16 v[122:123], v198 offset:18432
    v_mfma_f32_16x16x32_bf16 v[52:55], v[184:187], v[68:71], v[52:55]
    s_waitcnt lgkmcnt(14)
    ds_read_b64_tr_b16 v[124:125], v199 offset:16384
    s_waitcnt lgkmcnt(14)
    ds_read_b64_tr_b16 v[126:127], v199 offset:18432
    v_mfma_f32_16x16x32_bf16 v[56:59], v[188:191], v[64:67], v[56:59]
    v_mfma_f32_16x16x32_bf16 v[60:63], v[188:191], v[68:71], v[60:63]
    buffer_load_dwordx4 v221, s[12:15], s64 offen offset:1024 nt lds
    s_waitcnt lgkmcnt(0)
    s_waitcnt vmcnt(6)
    s_barrier
    v_mfma_f32_16x16x32_bf16 v[0:3], v[96:99], v[72:75], v[0:3]
    ds_read_b128 v[64:67], v88 offset:32768
    ds_read_b64_tr_b16 v[160:161], v192 offset:32768
    v_mfma_f32_16x16x32_bf16 v[4:7], v[96:99], v[76:79], v[4:7]
    ds_read_b64_tr_b16 v[162:163], v192 offset:34816
    v_mfma_f32_16x16x32_bf16 v[8:11], v[100:103], v[72:75], v[8:11]
    ds_read_b128 v[68:71], v88 offset:34816
    ds_read_b64_tr_b16 v[164:165], v193 offset:32768
    v_mfma_f32_16x16x32_bf16 v[12:15], v[100:103], v[76:79], v[12:15]
    ds_read_b64_tr_b16 v[166:167], v193 offset:34816
    v_mfma_f32_16x16x32_bf16 v[16:19], v[104:107], v[72:75], v[16:19]
    ds_read_b64_tr_b16 v[168:169], v194 offset:32768
    v_mfma_f32_16x16x32_bf16 v[20:23], v[104:107], v[76:79], v[20:23]
    ds_read_b64_tr_b16 v[170:171], v194 offset:34816
    v_mfma_f32_16x16x32_bf16 v[24:27], v[108:111], v[72:75], v[24:27]
    ds_read_b64_tr_b16 v[172:173], v195 offset:32768
    v_mfma_f32_16x16x32_bf16 v[28:31], v[108:111], v[76:79], v[28:31]
    ds_read_b64_tr_b16 v[174:175], v195 offset:34816
    s_add_u32 m0, s79, 65536
    s_add_u32 s64, s76, 32768
    buffer_load_dwordx4 v94, s[8:11], s64 offen offset:0 nt lds
    v_mfma_f32_16x16x32_bf16 v[32:35], v[112:115], v[72:75], v[32:35]
    ds_read_b64_tr_b16 v[176:177], v196 offset:32768
    v_mfma_f32_16x16x32_bf16 v[36:39], v[112:115], v[76:79], v[36:39]
    ds_read_b64_tr_b16 v[178:179], v196 offset:34816
    v_mfma_f32_16x16x32_bf16 v[40:43], v[116:119], v[72:75], v[40:43]
    ds_read_b64_tr_b16 v[180:181], v197 offset:32768
    v_mfma_f32_16x16x32_bf16 v[44:47], v[116:119], v[76:79], v[44:47]
    ds_read_b64_tr_b16 v[182:183], v197 offset:34816
    v_mfma_f32_16x16x32_bf16 v[48:51], v[120:123], v[72:75], v[48:51]
    ds_read_b64_tr_b16 v[184:185], v198 offset:32768
    s_waitcnt lgkmcnt(14)
    ds_read_b64_tr_b16 v[186:187], v198 offset:34816
    v_mfma_f32_16x16x32_bf16 v[52:55], v[120:123], v[76:79], v[52:55]
    s_waitcnt lgkmcnt(14)
    ds_read_b64_tr_b16 v[188:189], v199 offset:32768
    s_waitcnt lgkmcnt(14)
    ds_read_b64_tr_b16 v[190:191], v199 offset:34816
    v_mfma_f32_16x16x32_bf16 v[56:59], v[124:127], v[72:75], v[56:59]
    v_mfma_f32_16x16x32_bf16 v[60:63], v[124:127], v[76:79], v[60:63]
    buffer_load_dwordx4 v95, s[8:11], s64 offen offset:1024 nt lds
    s_waitcnt lgkmcnt(0)
    s_waitcnt vmcnt(6)
    s_barrier
    s_cbranch_vccnz L_np
    s_setprio 1
L_np:
    v_mfma_f32_16x16x32_bf16 v[0:3], v[160:163], v[64:67], v[0:3]
    ds_read_b128 v[72:75], v89 offset:32768
    ds_read_b64_tr_b16 v[96:97], v192 offset:49152
    v_mfma_f32_16x16x32_bf16 v[4:7], v[160:163], v[68:71], v[4:7]
    ds_read_b64_tr_b16 v[98:99], v192 offset:51200
    v_mfma_f32_16x16x32_bf16 v[8:11], v[164:167], v[64:67], v[8:11]
    ds_read_b128 v[76:79], v89 offset:34816
    ds_read_b64_tr_b16 v[100:101], v193 offset:49152
    v_mfma_f32_16x16x32_bf16 v[12:15], v[164:167], v[68:71], v[12:15]
    ds_read_b64_tr_b16 v[102:103], v193 offset:51200
    v_mfma_f32_16x16x32_bf16 v[16:19], v[168:171], v[64:67], v[16:19]
    ds_read_b64_tr_b16 v[104:105], v194 offset:49152
    v_mfma_f32_16x16x32_bf16 v[20:23], v[168:171], v[68:71], v[20:23]
    ds_read_b64_tr_b16 v[106:107], v194 offset:51200
    v_mfma_f32_16x16x32_bf16 v[24:27], v[172:175], v[64:67], v[24:27]
    ds_read_b64_tr_b16 v[108:109], v195 offset:49152
    v_mfma_f32_16x16x32_bf16 v[28:31], v[172:175], v[68:71], v[28:31]
    ds_read_b64_tr_b16 v[110:111], v195 offset:51200
    s_add_u32 m0, s79, 98304
    s_add_u32 s64, s76, 49152
    buffer_load_dwordx4 v94, s[8:11], s64 offen offset:0 nt lds
    v_mfma_f32_16x16x32_bf16 v[32:35], v[176:179], v[64:67], v[32:35]
    ds_read_b64_tr_b16 v[112:113], v196 offset:49152
    v_mfma_f32_16x16x32_bf16 v[36:39], v[176:179], v[68:71], v[36:39]
    ds_read_b64_tr_b16 v[114:115], v196 offset:51200
    v_mfma_f32_16x16x32_bf16 v[40:43], v[180:183], v[64:67], v[40:43]
    ds_read_b64_tr_b16 v[116:117], v197 offset:49152
    v_mfma_f32_16x16x32_bf16 v[44:47], v[180:183], v[68:71], v[44:47]
    ds_read_b64_tr_b16 v[118:119], v197 offset:51200
    v_mfma_f32_16x16x32_bf16 v[48:51], v[184:187], v[64:67], v[48:51]
    ds_read_b64_tr_b16 v[120:121], v198 offset:49152
    s_waitcnt lgkmcnt(14)
    ds_read_b64_tr_b16 v[122:123], v198 offset:51200
    v_mfma_f32_16x16x32_bf16 v[52:55], v[184:187], v[68:71], v[52:55]
    s_waitcnt lgkmcnt(14)
    ds_read_b64_tr_b16 v[124:125], v199 offset:49152
    s_waitcnt lgkmcnt(14)
    ds_read_b64_tr_b16 v[126:127], v199 offset:51200
    v_mfma_f32_16x16x32_bf16 v[56:59], v[188:191], v[64:67], v[56:59]
    v_mfma_f32_16x16x32_bf16 v[60:63], v[188:191], v[68:71], v[60:63]
    buffer_load_dwordx4 v95, s[8:11], s64 offen offset:1024 nt lds
    s_waitcnt lgkmcnt(0)
    v_mfma_f32_16x16x32_bf16 v[0:3], v[96:99], v[72:75], v[0:3]
    v_mfma_f32_16x16x32_bf16 v[4:7], v[96:99], v[76:79], v[4:7]
    v_mfma_f32_16x16x32_bf16 v[8:11], v[100:103], v[72:75], v[8:11]
    v_mfma_f32_16x16x32_bf16 v[12:15], v[100:103], v[76:79], v[12:15]
    v_mfma_f32_16x16x32_bf16 v[16:19], v[104:107], v[72:75], v[16:19]
    v_mfma_f32_16x16x32_bf16 v[20:23], v[104:107], v[76:79], v[20:23]
    v_mfma_f32_16x16x32_bf16 v[24:27], v[108:111], v[72:75], v[24:27]
    v_mfma_f32_16x16x32_bf16 v[28:31], v[108:111], v[76:79], v[28:31]
    v_mfma_f32_16x16x32_bf16 v[32:35], v[112:115], v[72:75], v[32:35]
    v_mfma_f32_16x16x32_bf16 v[36:39], v[112:115], v[76:79], v[36:39]
    v_mfma_f32_16x16x32_bf16 v[40:43], v[116:119], v[72:75], v[40:43]
    v_mfma_f32_16x16x32_bf16 v[44:47], v[116:119], v[76:79], v[44:47]
    v_mfma_f32_16x16x32_bf16 v[48:51], v[120:123], v[72:75], v[48:51]
    v_mfma_f32_16x16x32_bf16 v[52:55], v[120:123], v[76:79], v[52:55]
    v_mfma_f32_16x16x32_bf16 v[56:59], v[124:127], v[72:75], v[56:59]
    v_mfma_f32_16x16x32_bf16 v[60:63], v[124:127], v[76:79], v[60:63]
    s_waitcnt vmcnt(40)
    s_cmp_eq_u32 s4, 0
    s_cbranch_scc1 L_g0
    s_setprio 2
    s_add_u32 s55, s68, 81920
    s_add_u32 s54, s68, 98304
    s_add_u32 s52, s52, 32768
    s_barrier
    s_mov_b32 m0, s55
    s_waitcnt vmcnt(4)
    buffer_load_dwordx4 v220, s[12:15], s52 offen offset:0 nt lds
    v_mul_f32 v0, s61, v0
    v_mul_f32 v1, s61, v1
    v_mul_f32 v2, s61, v2
    v_mul_f32 v3, s61, v3
    v_cvt_pk_bf16_f32 v128, v0, v1
    v_cvt_pk_bf16_f32 v129, v2, v3
    v_mul_f32 v8, s61, v8
    v_mul_f32 v9, s61, v9
    v_mul_f32 v10, s61, v10
    v_mul_f32 v11, s61, v11
    v_cvt_pk_bf16_f32 v130, v8, v9
    v_cvt_pk_bf16_f32 v131, v10, v11
    v_mul_f32 v4, s61, v4
    v_mul_f32 v5, s61, v5
    v_mul_f32 v6, s61, v6
    v_mul_f32 v7, s61, v7
    s_waitcnt vmcnt(4)
    buffer_load_dwordx4 v221, s[12:15], s52 offen offset:1024 nt lds
    v_cvt_pk_bf16_f32 v132, v4, v5
    v_cvt_pk_bf16_f32 v133, v6, v7
    v_mul_f32 v12, s61, v12
    v_mul_f32 v13, s61, v13
    v_mul_f32 v14, s61, v14
    v_mul_f32 v15, s61, v15
    v_cvt_pk_bf16_f32 v134, v12, v13
    v_cvt_pk_bf16_f32 v135, v14, v15
    v_mul_f32 v16, s61, v16
    v_mul_f32 v17, s61, v17
    v_mul_f32 v18, s61, v18
    v_mul_f32 v19, s61, v19
    v_cvt_pk_bf16_f32 v136, v16, v17
    v_cvt_pk_bf16_f32 v137, v18, v19
    v_mul_f32 v24, s61, v24
    v_mul_f32 v25, s61, v25
    s_waitcnt vmcnt(4)
    buffer_load_dwordx4 v220, s[12:15], s52 offen offset:2048 nt lds
    v_mul_f32 v26, s61, v26
    v_mul_f32 v27, s61, v27
    v_cvt_pk_bf16_f32 v138, v24, v25
    v_cvt_pk_bf16_f32 v139, v26, v27
    v_mul_f32 v20, s61, v20
    v_mul_f32 v21, s61, v21
    v_mul_f32 v22, s61, v22
    v_mul_f32 v23, s61, v23
    v_cvt_pk_bf16_f32 v140, v20, v21
    v_cvt_pk_bf16_f32 v141, v22, v23
    v_mul_f32 v28, s61, v28
    v_mul_f32 v29, s61, v29
    v_mul_f32 v30, s61, v30
    v_mul_f32 v31, s61, v31
    v_cvt_pk_bf16_f32 v142, v28, v29
    v_cvt_pk_bf16_f32 v143, v30, v31
    s_waitcnt vmcnt(4)
    buffer_load_dwordx4 v221, s[12:15], s52 offen offset:3072 nt lds
    v_mul_f32 v32, s61, v32
    v_mul_f32 v33, s61, v33
    v_mul_f32 v34, s61, v34
    v_mul_f32 v35, s61, v35
    v_cvt_pk_bf16_f32 v144, v32, v33
    v_cvt_pk_bf16_f32 v145, v34, v35
    v_mul_f32 v40, s61, v40
    v_mul_f32 v41, s61, v41
    v_mul_f32 v42, s61, v42
    v_mul_f32 v43, s61, v43
    v_cvt_pk_bf16_f32 v146, v40, v41
    v_cvt_pk_bf16_f32 v147, v42, v43
    v_mul_f32 v36, s61, v36
    v_mul_f32 v37, s61, v37
    v_mul_f32 v38, s61, v38
    v_mul_f32 v39, s61, v39
    s_add_u32 s55, s55, 32768
    s_add_u32 s52, s52, 16384
    s_mov_b32 m0, s55
    s_waitcnt vmcnt(4)
    buffer_load_dwordx4 v220, s[12:15], s52 offen offset:0 nt lds
    v_cvt_pk_bf16_f32 v148, v36, v37
    v_cvt_pk_bf16_f32 v149, v38, v39
    v_mul_f32 v44, s61, v44
    v_mul_f32 v45, s61, v45
    v_mul_f32 v46, s61, v46
    v_mul_f32 v47, s61, v47
    v_cvt_pk_bf16_f32 v150, v44, v45
    v_cvt_pk_bf16_f32 v151, v46, v47
    v_mul_f32 v48, s61, v48
    v_mul_f32 v49, s61, v49
    v_mul_f32 v50, s61, v50
    v_mul_f32 v51, s61, v51
    v_cvt_pk_bf16_f32 v152, v48, v49
    v_cvt_pk_bf16_f32 v153, v50, v51
    v_mul_f32 v56, s61, v56
    v_mul_f32 v57, s61, v57
    s_waitcnt vmcnt(4)
    buffer_load_dwordx4 v221, s[12:15], s52 offen offset:1024 nt lds
    v_mul_f32 v58, s61, v58
    v_mul_f32 v59, s61, v59
    v_cvt_pk_bf16_f32 v154, v56, v57
    v_cvt_pk_bf16_f32 v155, v58, v59
    v_mul_f32 v52, s61, v52
    v_mul_f32 v53, s61, v53
    v_mul_f32 v54, s61, v54
    v_mul_f32 v55, s61, v55
    v_cvt_pk_bf16_f32 v156, v52, v53
    v_cvt_pk_bf16_f32 v157, v54, v55
    v_mul_f32 v60, s61, v60
    v_mul_f32 v61, s61, v61
    v_mul_f32 v62, s61, v62
    v_mul_f32 v63, s61, v63
    v_cvt_pk_bf16_f32 v158, v60, v61
    v_cvt_pk_bf16_f32 v159, v62, v63
    s_waitcnt vmcnt(4)
    buffer_load_dwordx4 v220, s[12:15], s52 offen offset:2048 nt lds
    v_permlane32_swap_b32 v128, v130
    v_permlane32_swap_b32 v129, v131
    v_permlane32_swap_b32 v132, v134
    v_permlane32_swap_b32 v133, v135
    v_permlane32_swap_b32 v136, v138
    v_permlane32_swap_b32 v137, v139
    v_permlane32_swap_b32 v140, v142
    v_permlane32_swap_b32 v141, v143
    v_permlane32_swap_b32 v144, v146
    v_permlane32_swap_b32 v145, v147
    v_permlane32_swap_b32 v148, v150
    v_permlane32_swap_b32 v149, v151
    v_permlane32_swap_b32 v152, v154
    v_permlane32_swap_b32 v153, v155
    v_permlane32_swap_b32 v156, v158
    v_permlane32_swap_b32 v157, v159
    s_waitcnt vmcnt(4)
    buffer_load_dwordx4 v221, s[12:15], s52 offen offset:3072 nt lds
    v_permlane16_swap_b32 v128, v130
    v_permlane16_swap_b32 v129, v131
    v_permlane16_swap_b32 v132, v134
    v_permlane16_swap_b32 v133, v135
    v_permlane16_swap_b32 v136, v138
    v_permlane16_swap_b32 v137, v139
    v_permlane16_swap_b32 v140, v142
    v_permlane16_swap_b32 v141, v143
    v_permlane16_swap_b32 v144, v146
    v_permlane16_swap_b32 v145, v147
    v_permlane16_swap_b32 v148, v150
    v_permlane16_swap_b32 v149, v151
    v_permlane16_swap_b32 v152, v154
    v_permlane16_swap_b32 v153, v155
    v_permlane16_swap_b32 v156, v158
    v_permlane16_swap_b32 v157, v159
    s_waitcnt vmcnt(8)
    s_mov_b32 s60, 15
L_g1l:
    s_barrier
    s_add_u32 s54, s54, 32768
    s_add_u32 s66, s68, 163840
    s_cmp_eq_u32 s54, s66
    s_cselect_b32 s54, s68, s54
    s_add_u32 s55, s54, 16384
    s_add_u32 s52, s52, 16384
    s_mov_b32 m0, s54
    s_waitcnt vmcnt(4)
    buffer_load_dwordx4 v216, s[8:11], s52 offen offset:0 nt lds
    s_waitcnt vmcnt(4)
    buffer_load_dwordx4 v217, s[8:11], s52 offen offset:1024 nt lds
    s_waitcnt vmcnt(4)
    buffer_load_dwordx4 v218, s[8:11], s52 offen offset:2048 nt lds
    s_waitcnt vmcnt(4)
    buffer_load_dwordx4 v219, s[8:11], s52 offen offset:3072 nt lds
    s_mov_b32 m0, s55
    s_waitcnt vmcnt(4)
    buffer_load_dwordx4 v220, s[12:15], s52 offen offset:0 nt lds
    s_waitcnt vmcnt(4)
    buffer_load_dwordx4 v221, s[12:15], s52 offen offset:1024 nt lds
    s_waitcnt vmcnt(4)
    buffer_load_dwordx4 v220, s[12:15], s52 offen offset:2048 nt lds
    s_waitcnt vmcnt(4)
    buffer_load_dwordx4 v221, s[12:15], s52 offen offset:3072 nt lds
    s_waitcnt vmcnt(8)
    s_sub_u32 s60, s60, 1
    s_cmp_lg_u32 s60, 0
    s_cbranch_scc1 L_g1l
    s_barrier
    ds_read_b128 v[160:163], v224 offset:0
    ds_read_b128 v[164:167], v225 offset:0
    ds_read_b128 v[168:171], v226 offset:0
    ds_read_b128 v[172:175], v227 offset:0
    ds_read_b128 v[176:179], v224 offset:4096
    ds_read_b128 v[180:183], v225 offset:4096
    ds_read_b128 v[184:187], v226 offset:4096
    ds_read_b128 v[188:191], v227 offset:4096
    s_add_u32 s54, s54, 32768
    s_add_u32 s66, s68, 163840
    s_cmp_eq_u32 s54, s66
    s_cselect_b32 s54, s68, s54
    s_add_u32 s55, s54, 16384
    s_add_u32 s52, s52, 16384
    s_mov_b32 m0, s54
    s_waitcnt vmcnt(4)
    buffer_load_dwordx4 v216, s[8:11], s52 offen offset:0 nt lds
    s_mov_b32 s65, s64
    s_cmp_eq_u32 s63, 131072
    s_cselect_b32 s64, 0xfffe0000, s7
    s_add_u32 s63, s63, s64
    v_mov_b32 v0, 0
    v_mov_b32 v1, 0
    v_mov_b32 v2, 0
    v_mov_b32 v3, 0
    v_mov_b32 v4, 0
    v_mov_b32 v5, 0
    v_mov_b32 v6, 0
    v_mov_b32 v7, 0
    v_mov_b32 v8, 0
    v_mov_b32 v9, 0
    s_waitcnt vmcnt(4)
    buffer_load_dwordx4 v217, s[8:11], s52 offen offset:1024 nt lds
    v_mov_b32 v10, 0
    v_mov_b32 v11, 0
    v_mov_b32 v12, 0
    v_mov_b32 v13, 0
    v_mov_b32 v14, 0
    v_mov_b32 v15, 0
    v_mov_b32 v16, 0
    v_mov_b32 v17, 0
    s_waitcnt lgkmcnt(7)
    v_mfma_f32_16x16x32_bf16 v[64:67], v[160:163], v[128:131], 0
    v_mov_b32 v18, 0
    v_mov_b32 v19, 0
    v_mfma_f32_16x16x32_bf16 v[72:75], v[160:163], v[132:135], 0
    v_mov_b32 v20, 0
    ds_read_b128 v[160:163], v224 offset:8192
    s_waitcnt vmcnt(4)
    buffer_load_dwordx4 v218, s[8:11], s52 offen offset:2048 nt lds
    s_waitcnt lgkmcnt(7)
    v_mfma_f32_16x16x32_bf16 v[72:75], v[164:167], v[140:143], v[72:75]
    v_mov_b32 v21, 0
    v_mov_b32 v22, 0
    v_mfma_f32_16x16x32_bf16 v[64:67], v[164:167], v[136:139], v[64:67]
    v_mov_b32 v23, 0
    ds_read_b128 v[164:167], v225 offset:8192
    s_waitcnt lgkmcnt(7)
    v_mfma_f32_16x16x32_bf16 v[64:67], v[168:171], v[144:147], v[64:67]
    v_mov_b32 v24, 0
    v_mov_b32 v25, 0
    v_mfma_f32_16x16x32_bf16 v[72:75], v[168:171], v[148:151], v[72:75]
    v_mov_b32 v26, 0
    ds_read_b128 v[168:171], v226 offset:8192
    s_waitcnt lgkmcnt(7)
    v_mfma_f32_16x16x32_bf16 v[72:75], v[172:175], v[156:159], v[72:75]
    v_mov_b32 v27, 0
    s_waitcnt vmcnt(4)
    buffer_load_dwordx4 v219, s[8:11], s52 offen offset:3072 nt lds
    v_mov_b32 v28, 0
    v_mfma_f32_16x16x32_bf16 v[64:67], v[172:175], v[152:155], v[64:67]
    v_mov_b32 v29, 0
    ds_read_b128 v[172:175], v227 offset:8192
    s_waitcnt lgkmcnt(7)
    v_mfma_f32_16x16x32_bf16 v[68:71], v[176:179], v[128:131], 0
    v_mov_b32 v30, 0
    v_mov_b32 v31, 0
    v_mfma_f32_16x16x32_bf16 v[76:79], v[176:179], v[132:135], 0
    v_mov_b32 v32, 0
    ds_read_b128 v[176:179], v224 offset:12288
    s_waitcnt lgkmcnt(7)
    v_mfma_f32_16x16x32_bf16 v[76:79], v[180:183], v[140:143], v[76:79]
    v_mov_b32 v33, 0
    v_mov_b32 v34, 0
    v_mfma_f32_16x16x32_bf16 v[68:71], v[180:183], v[136:139], v[68:71]
    v_mov_b32 v35, 0
    s_mov_b32 m0, s55
    s_waitcnt vmcnt(4)
    buffer_load_dwordx4 v220, s[12:15], s52 offen offset:0 nt lds
    ds_read_b128 v[180:183], v225 offset:12288
    s_waitcnt lgkmcnt(7)
    v_mfma_f32_16x16x32_bf16 v[68:71], v[184:187], v[144:147], v[68:71]
    v_mov_b32 v36, 0
    v_mov_b32 v37, 0
    v_mfma_f32_16x16x32_bf16 v[76:79], v[184:187], v[148:151], v[76:79]
    v_mov_b32 v38, 0
    ds_read_b128 v[184:187], v226 offset:12288
    s_waitcnt lgkmcnt(7)
    v_mfma_f32_16x16x32_bf16 v[76:79], v[188:191], v[156:159], v[76:79]
    v_mov_b32 v39, 0
    v_mov_b32 v40, 0
    v_mfma_f32_16x16x32_bf16 v[68:71], v[188:191], v[152:155], v[68:71]
    v_mov_b32 v41, 0
    ds_read_b128 v[188:191], v227 offset:12288
    s_waitcnt lgkmcnt(7)
    v_mfma_f32_16x16x32_bf16 v[80:83], v[160:163], v[128:131], 0
    s_waitcnt vmcnt(4)
    buffer_load_dwordx4 v221, s[12:15], s52 offen offset:1024 nt lds
    v_mov_b32 v42, 0
    v_mov_b32 v43, 0
    v_mfma_f32_16x16x32_bf16 v[88:91], v[160:163], v[132:135], 0
    v_mov_b32 v44, 0
    s_waitcnt lgkmcnt(6)
    v_mfma_f32_16x16x32_bf16 v[88:91], v[164:167], v[140:143], v[88:91]
    v_mov_b32 v45, 0
    v_mov_b32 v46, 0
    v_mfma_f32_16x16x32_bf16 v[80:83], v[164:167], v[136:139], v[80:83]
    v_mov_b32 v47, 0
    s_waitcnt lgkmcnt(5)
    v_mfma_f32_16x16x32_bf16 v[80:83], v[168:171], v[144:147], v[80:83]
    v_mov_b32 v48, 0
    v_mov_b32 v49, 0
    v_mfma_f32_16x16x32_bf16 v[88:91], v[168:171], v[148:151], v[88:91]
    v_mov_b32 v50, 0
    s_waitcnt vmcnt(4)
    buffer_load_dwordx4 v220, s[12:15], s52 offen offset:2048 nt lds
    s_waitcnt lgkmcnt(4)
    v_mfma_f32_16x16x32_bf16 v[88:91], v[172:175], v[156:159], v[88:91]
    v_mov_b32 v51, 0
    v_mov_b32 v52, 0
    v_mfma_f32_16x16x32_bf16 v[80:83], v[172:175], v[152:155], v[80:83]
    v_mov_b32 v53, 0
    s_waitcnt lgkmcnt(3)
    v_mfma_f32_16x16x32_bf16 v[84:87], v[176:179], v[128:131], 0
    v_mov_b32 v54, 0
    v_mov_b32 v55, 0
    v_mfma_f32_16x16x32_bf16 v[92:95], v[176:179], v[132:135], 0
    v_mov_b32 v56, 0
    v_add_u32 v224, s64, v224
    s_waitcnt lgkmcnt(2)
    v_mfma_f32_16x16x32_bf16 v[92:95], v[180:183], v[140:143], v[92:95]
    v_mov_b32 v57, 0
    v_mov_b32 v58, 0
    s_waitcnt vmcnt(4)
    buffer_load_dwordx4 v221, s[12:15], s52 offen offset:3072 nt lds
    v_mfma_f32_16x16x32_bf16 v[84:87], v[180:183], v[136:139], v[84:87]
    v_mov_b32 v59, 0
    v_add_u32 v225, s64, v225
    s_waitcnt lgkmcnt(1)
    v_mfma_f32_16x16x32_bf16 v[84:87], v[184:187], v[144:147], v[84:87]
    v_mov_b32 v60, 0
    v_mov_b32 v61, 0
    v_mfma_f32_16x16x32_bf16 v[92:95], v[184:187], v[148:151], v[92:95]
    v_mov_b32 v62, 0
    v_add_u32 v226, s64, v226
    s_waitcnt lgkmcnt(0)
    v_mfma_f32_16x16x32_bf16 v[92:95], v[188:191], v[156:159], v[92:95]
    v_mov_b32 v63, 0
    v_mov_b32 v245, 0
    v_mfma_f32_16x16x32_bf16 v[84:87], v[188:191], v[152:155], v[84:87]
    v_mov_b32 v246, 0
    v_add_u32 v227, s64, v227
    v_max3_f32 v247, v64, v65, v66
    v_max3_f32 v248, v72, v73, v74
    v_max3_f32 v247, v247, v67, v68
    v_max3_f32 v248, v248, v75, v76
    v_max3_f32 v247, v247, v69, v70
    v_max3_f32 v248, v248, v77, v78
    v_max_f32 v247, v247, v71
    v_max_f32 v248, v248, v79
    v_max3_f32 v247, v247, v80, v81
    v_max3_f32 v248, v248, v88, v89
    v_max3_f32 v247, v247, v82, v83
    v_max3_f32 v248, v248, v90, v91
    v_max3_f32 v247, v247, v84, v85
    v_max3_f32 v248, v248, v92, v93
    v_max3_f32 v247, v247, v86, v87
    v_max3_f32 v248, v248, v94, v95
    s_nop 1
    v_permlane32_swap_b32 v247, v248
    v_max_f32 v247, v247, v248
    v_mov_b32 v248, v247
    s_nop 1
    v_permlane16_swap_b32 v247, v248
    v_max_f32 v247, v247, v248
    v_mov_b32 v250, v247
    v_mov_b32 v251, v247
    s_nop 1
    v_permlane32_swap_b32 v250, v251
    v_sub_f32 v236, 0, v250
    v_sub_f32 v237, 0, v250
    v_sub_f32 v238, 0, v250
    v_sub_f32 v239, 0, v250
    v_sub_f32 v64, v64, v250
    v_sub_f32 v65, v65, v250
    v_sub_f32 v66, v66, v250
    v_sub_f32 v67, v67, v250
    v_sub_f32 v68, v68, v250
    v_sub_f32 v69, v69, v250
    v_sub_f32 v70, v70, v250
    v_sub_f32 v71, v71, v250
    v_sub_f32 v80, v80, v250
    v_sub_f32 v81, v81, v250
    v_sub_f32 v82, v82, v250
    v_sub_f32 v83, v83, v250
    v_sub_f32 v84, v84, v250
    v_sub_f32 v85, v85, v250
    v_sub_f32 v86, v86, v250
    v_sub_f32 v87, v87, v250
    v_sub_f32 v240, 0, v251
    v_sub_f32 v241, 0, v251
    v_sub_f32 v242, 0, v251
    v_sub_f32 v243, 0, v251
    v_sub_f32 v72, v72, v251
    v_sub_f32 v73, v73, v251
    v_sub_f32 v74, v74, v251
    v_sub_f32 v75, v75, v251
    v_sub_f32 v76, v76, v251
    v_sub_f32 v77, v77, v251
    v_sub_f32 v78, v78, v251
    v_sub_f32 v79, v79, v251
    v_sub_f32 v88, v88, v251
    v_sub_f32 v89, v89, v251
    v_sub_f32 v90, v90, v251
    v_sub_f32 v91, v91, v251
    v_sub_f32 v92, v92, v251
    v_sub_f32 v93, v93, v251
    v_sub_f32 v94, v94, v251
    v_sub_f32 v95, v95, v251
    s_waitcnt vmcnt(8)
    s_setprio 1
    s_branch L_attn
L_g0:
    v_mul_f32 v0, s61, v0
    v_mul_f32 v1, s61, v1
    v_mul_f32 v2, s61, v2
    v_mul_f32 v3, s61, v3
    v_cvt_pk_bf16_f32 v128, v0, v1
    v_cvt_pk_bf16_f32 v129, v2, v3
    v_mul_f32 v8, s61, v8
    v_mul_f32 v9, s61, v9
    v_mul_f32 v10, s61, v10
    v_mul_f32 v11, s61, v11
    v_cvt_pk_bf16_f32 v130, v8, v9
    v_cvt_pk_bf16_f32 v131, v10, v11
    v_mul_f32 v4, s61, v4
    v_mul_f32 v5, s61, v5
    v_mul_f32 v6, s61, v6
    v_mul_f32 v7, s61, v7
    v_cvt_pk_bf16_f32 v132, v4, v5
    v_cvt_pk_bf16_f32 v133, v6, v7
    v_mul_f32 v12, s61, v12
    v_mul_f32 v13, s61, v13
    v_mul_f32 v14, s61, v14
    v_mul_f32 v15, s61, v15
    v_cvt_pk_bf16_f32 v134, v12, v13
    v_cvt_pk_bf16_f32 v135, v14, v15
    v_mul_f32 v16, s61, v16
    v_mul_f32 v17, s61, v17
    v_mul_f32 v18, s61, v18
    v_mul_f32 v19, s61, v19
    v_cvt_pk_bf16_f32 v136, v16, v17
    v_cvt_pk_bf16_f32 v137, v18, v19
    v_mul_f32 v24, s61, v24
    v_mul_f32 v25, s61, v25
    v_mul_f32 v26, s61, v26
    v_mul_f32 v27, s61, v27
    v_cvt_pk_bf16_f32 v138, v24, v25
    v_cvt_pk_bf16_f32 v139, v26, v27
    v_mul_f32 v20, s61, v20
    v_mul_f32 v21, s61, v21
    v_mul_f32 v22, s61, v22
    v_mul_f32 v23, s61, v23
    v_cvt_pk_bf16_f32 v140, v20, v21
    v_cvt_pk_bf16_f32 v141, v22, v23
    v_mul_f32 v28, s61, v28
    v_mul_f32 v29, s61, v29
    v_mul_f32 v30, s61, v30
    v_mul_f32 v31, s61, v31
    v_cvt_pk_bf16_f32 v142, v28, v29
    v_cvt_pk_bf16_f32 v143, v30, v31
    v_mul_f32 v32, s61, v32
    v_mul_f32 v33, s61, v33
    v_mul_f32 v34, s61, v34
    v_mul_f32 v35, s61, v35
    v_cvt_pk_bf16_f32 v144, v32, v33
    v_cvt_pk_bf16_f32 v145, v34, v35
    v_mul_f32 v40, s61, v40
    v_mul_f32 v41, s61, v41
    v_mul_f32 v42, s61, v42
    v_mul_f32 v43, s61, v43
    v_cvt_pk_bf16_f32 v146, v40, v41
    v_cvt_pk_bf16_f32 v147, v42, v43
    v_mul_f32 v36, s61, v36
    v_mul_f32 v37, s61, v37
    v_mul_f32 v38, s61, v38
    v_mul_f32 v39, s61, v39
    v_cvt_pk_bf16_f32 v148, v36, v37
    v_cvt_pk_bf16_f32 v149, v38, v39
    v_mul_f32 v44, s61, v44
    v_mul_f32 v45, s61, v45
    v_mul_f32 v46, s61, v46
    v_mul_f32 v47, s61, v47
    v_cvt_pk_bf16_f32 v150, v44, v45
    v_cvt_pk_bf16_f32 v151, v46, v47
    v_mul_f32 v48, s61, v48
    v_mul_f32 v49, s61, v49
    v_mul_f32 v50, s61, v50
    v_mul_f32 v51, s61, v51
    v_cvt_pk_bf16_f32 v152, v48, v49
    v_cvt_pk_bf16_f32 v153, v50, v51
    v_mul_f32 v56, s61, v56
    v_mul_f32 v57, s61, v57
    v_mul_f32 v58, s61, v58
    v_mul_f32 v59, s61, v59
    v_cvt_pk_bf16_f32 v154, v56, v57
    v_cvt_pk_bf16_f32 v155, v58, v59
    v_mul_f32 v52, s61, v52
    v_mul_f32 v53, s61, v53
    v_mul_f32 v54, s61, v54
    v_mul_f32 v55, s61, v55
    v_cvt_pk_bf16_f32 v156, v52, v53
    v_cvt_pk_bf16_f32 v157, v54, v55
    v_mul_f32 v60, s61, v60
    v_mul_f32 v61, s61, v61
    v_mul_f32 v62, s61, v62
    v_mul_f32 v63, s61, v63
    v_cvt_pk_bf16_f32 v158, v60, v61
    v_cvt_pk_bf16_f32 v159, v62, v63
    v_permlane32_swap_b32 v128, v130
    v_permlane32_swap_b32 v129, v131
    v_permlane32_swap_b32 v132, v134
    v_permlane32_swap_b32 v133, v135
    v_permlane32_swap_b32 v136, v138
    v_permlane32_swap_b32 v137, v139
    v_permlane32_swap_b32 v140, v142
    v_permlane32_swap_b32 v141, v143
    v_permlane32_swap_b32 v144, v146
    v_permlane32_swap_b32 v145, v147
    v_permlane32_swap_b32 v148, v150
    v_permlane32_swap_b32 v149, v151
    v_permlane32_swap_b32 v152, v154
    v_permlane32_swap_b32 v153, v155
    v_permlane32_swap_b32 v156, v158
    v_permlane32_swap_b32 v157, v159
    v_permlane16_swap_b32 v128, v130
    v_permlane16_swap_b32 v129, v131
    v_permlane16_swap_b32 v132, v134
    v_permlane16_swap_b32 v133, v135
    v_permlane16_swap_b32 v136, v138
    v_permlane16_swap_b32 v137, v139
    v_permlane16_swap_b32 v140, v142
    v_permlane16_swap_b32 v141, v143
    v_permlane16_swap_b32 v144, v146
    v_permlane16_swap_b32 v145, v147
    v_permlane16_swap_b32 v148, v150
    v_permlane16_swap_b32 v149, v151
    v_permlane16_swap_b32 v152, v154
    v_permlane16_swap_b32 v153, v155
    v_permlane16_swap_b32 v156, v158
    v_permlane16_swap_b32 v157, v159
    s_setprio 1
    s_barrier
    ds_read_b128 v[160:163], v224 offset:0
    ds_read_b128 v[164:167], v225 offset:0
    ds_read_b128 v[168:171], v226 offset:0
    ds_read_b128 v[172:175], v227 offset:0
    ds_read_b128 v[176:179], v224 offset:4096
    ds_read_b128 v[180:183], v225 offset:4096
    ds_read_b128 v[184:187], v226 offset:4096
    ds_read_b128 v[188:191], v227 offset:4096
    s_mov_b32 s65, s64
    s_cmp_eq_u32 s63, 131072
    s_cselect_b32 s64, 0xfffe0000, s7
    s_add_u32 s63, s63, s64
    v_mov_b32 v0, 0
    v_mov_b32 v1, 0
    v_mov_b32 v2, 0
    v_mov_b32 v3, 0
    v_mov_b32 v4, 0
    v_mov_b32 v5, 0
    v_mov_b32 v6, 0
    v_mov_b32 v7, 0
    v_mov_b32 v8, 0
    v_mov_b32 v9, 0
    v_mov_b32 v10, 0
    v_mov_b32 v11, 0
    v_mov_b32 v12, 0
    v_mov_b32 v13, 0
    v_mov_b32 v14, 0
    v_mov_b32 v15, 0
    v_mov_b32 v16, 0
    v_mov_b32 v17, 0
    s_waitcnt lgkmcnt(7)
    v_mfma_f32_16x16x32_bf16 v[64:67], v[160:163], v[128:131], 0
    v_mov_b32 v18, 0
    v_mov_b32 v19, 0
    v_mfma_f32_16x16x32_bf16 v[72:75], v[160:163], v[132:135], 0
    v_mov_b32 v20, 0
    ds_read_b128 v[160:163], v224 offset:8192
    s_waitcnt lgkmcnt(7)
    v_mfma_f32_16x16x32_bf16 v[72:75], v[164:167], v[140:143], v[72:75]
    v_mov_b32 v21, 0
    v_mov_b32 v22, 0
    v_mfma_f32_16x16x32_bf16 v[64:67], v[164:167], v[136:139], v[64:67]
    v_mov_b32 v23, 0
    ds_read_b128 v[164:167], v225 offset:8192
    s_waitcnt lgkmcnt(7)
    v_mfma_f32_16x16x32_bf16 v[64:67], v[168:171], v[144:147], v[64:67]
    v_mov_b32 v24, 0
    v_mov_b32 v25, 0
    v_mfma_f32_16x16x32_bf16 v[72:75], v[168:171], v[148:151], v[72:75]
    v_mov_b32 v26, 0
    ds_read_b128 v[168:171], v226 offset:8192
    s_waitcnt lgkmcnt(7)
    v_mfma_f32_16x16x32_bf16 v[72:75], v[172:175], v[156:159], v[72:75]
    v_mov_b32 v27, 0
    v_mov_b32 v28, 0
    v_mfma_f32_16x16x32_bf16 v[64:67], v[172:175], v[152:155], v[64:67]
    v_mov_b32 v29, 0
    ds_read_b128 v[172:175], v227 offset:8192
    s_waitcnt lgkmcnt(7)
    v_mfma_f32_16x16x32_bf16 v[68:71], v[176:179], v[128:131], 0
    v_mov_b32 v30, 0
    v_mov_b32 v31, 0
    v_mfma_f32_16x16x32_bf16 v[76:79], v[176:179], v[132:135], 0
    v_mov_b32 v32, 0
    ds_read_b128 v[176:179], v224 offset:12288
    s_waitcnt lgkmcnt(7)
    v_mfma_f32_16x16x32_bf16 v[76:79], v[180:183], v[140:143], v[76:79]
    v_mov_b32 v33, 0
    v_mov_b32 v34, 0
    v_mfma_f32_16x16x32_bf16 v[68:71], v[180:183], v[136:139], v[68:71]
    v_mov_b32 v35, 0
    ds_read_b128 v[180:183], v225 offset:12288
    s_waitcnt lgkmcnt(7)
    v_mfma_f32_16x16x32_bf16 v[68:71], v[184:187], v[144:147], v[68:71]
    v_mov_b32 v36, 0
    v_mov_b32 v37, 0
    v_mfma_f32_16x16x32_bf16 v[76:79], v[184:187], v[148:151], v[76:79]
    v_mov_b32 v38, 0
    ds_read_b128 v[184:187], v226 offset:12288
    s_waitcnt lgkmcnt(7)
    v_mfma_f32_16x16x32_bf16 v[76:79], v[188:191], v[156:159], v[76:79]
    v_mov_b32 v39, 0
    v_mov_b32 v40, 0
    v_mfma_f32_16x16x32_bf16 v[68:71], v[188:191], v[152:155], v[68:71]
    v_mov_b32 v41, 0
    ds_read_b128 v[188:191], v227 offset:12288
    s_waitcnt lgkmcnt(7)
    v_mfma_f32_16x16x32_bf16 v[80:83], v[160:163], v[128:131], 0
    v_mov_b32 v42, 0
    v_mov_b32 v43, 0
    v_mfma_f32_16x16x32_bf16 v[88:91], v[160:163], v[132:135], 0
    v_mov_b32 v44, 0
    s_waitcnt lgkmcnt(6)
    v_mfma_f32_16x16x32_bf16 v[88:91], v[164:167], v[140:143], v[88:91]
    v_mov_b32 v45, 0
    v_mov_b32 v46, 0
    v_mfma_f32_16x16x32_bf16 v[80:83], v[164:167], v[136:139], v[80:83]
    v_mov_b32 v47, 0
    s_waitcnt lgkmcnt(5)
    v_mfma_f32_16x16x32_bf16 v[80:83], v[168:171], v[144:147], v[80:83]
    v_mov_b32 v48, 0
    v_mov_b32 v49, 0
    v_mfma_f32_16x16x32_bf16 v[88:91], v[168:171], v[148:151], v[88:91]
    v_mov_b32 v50, 0
    s_waitcnt lgkmcnt(4)
    v_mfma_f32_16x16x32_bf16 v[88:91], v[172:175], v[156:159], v[88:91]
    v_mov_b32 v51, 0
    v_mov_b32 v52, 0
    v_mfma_f32_16x16x32_bf16 v[80:83], v[172:175], v[152:155], v[80:83]
    v_mov_b32 v53, 0
    s_waitcnt lgkmcnt(3)
    v_mfma_f32_16x16x32_bf16 v[84:87], v[176:179], v[128:131], 0
    v_mov_b32 v54, 0
    v_mov_b32 v55, 0
    v_mfma_f32_16x16x32_bf16 v[92:95], v[176:179], v[132:135], 0
    v_mov_b32 v56, 0
    v_add_u32 v224, s64, v224
    s_waitcnt lgkmcnt(2)
    v_mfma_f32_16x16x32_bf16 v[92:95], v[180:183], v[140:143], v[92:95]
    v_mov_b32 v57, 0
    v_mov_b32 v58, 0
    v_mfma_f32_16x16x32_bf16 v[84:87], v[180:183], v[136:139], v[84:87]
    v_mov_b32 v59, 0
    v_add_u32 v225, s64, v225
    s_waitcnt lgkmcnt(1)
    v_mfma_f32_16x16x32_bf16 v[84:87], v[184:187], v[144:147], v[84:87]
    v_mov_b32 v60, 0
    v_mov_b32 v61, 0
    v_mfma_f32_16x16x32_bf16 v[92:95], v[184:187], v[148:151], v[92:95]
    v_mov_b32 v62, 0
    v_add_u32 v226, s64, v226
    s_waitcnt lgkmcnt(0)
    v_mfma_f32_16x16x32_bf16 v[92:95], v[188:191], v[156:159], v[92:95]
    v_mov_b32 v63, 0
    v_mov_b32 v245, 0
    v_mfma_f32_16x16x32_bf16 v[84:87], v[188:191], v[152:155], v[84:87]
    v_mov_b32 v246, 0
    v_add_u32 v227, s64, v227
    v_max3_f32 v247, v64, v65, v66
    v_max3_f32 v248, v72, v73, v74
    v_max3_f32 v247, v247, v67, v68
    v_max3_f32 v248, v248, v75, v76
    v_max3_f32 v247, v247, v69, v70
    v_max3_f32 v248, v248, v77, v78
    v_max_f32 v247, v247, v71
    v_max_f32 v248, v248, v79
    v_max3_f32 v247, v247, v80, v81
    v_max3_f32 v248, v248, v88, v89
    v_max3_f32 v247, v247, v82, v83
    v_max3_f32 v248, v248, v90, v91
    v_max3_f32 v247, v247, v84, v85
    v_max3_f32 v248, v248, v92, v93
    v_max3_f32 v247, v247, v86, v87
    v_max3_f32 v248, v248, v94, v95
    s_nop 1
    v_permlane32_swap_b32 v247, v248
    v_max_f32 v247, v247, v248
    v_mov_b32 v248, v247
    s_nop 1
    v_permlane16_swap_b32 v247, v248
    v_max_f32 v247, v247, v248
    v_mov_b32 v250, v247
    v_mov_b32 v251, v247
    s_nop 1
    v_permlane32_swap_b32 v250, v251
    v_sub_f32 v236, 0, v250
    v_sub_f32 v237, 0, v250
    v_sub_f32 v238, 0, v250
    v_sub_f32 v239, 0, v250
    v_sub_f32 v64, v64, v250
    v_sub_f32 v65, v65, v250
    v_sub_f32 v66, v66, v250
    v_sub_f32 v67, v67, v250
    v_sub_f32 v68, v68, v250
    v_sub_f32 v69, v69, v250
    v_sub_f32 v70, v70, v250
    v_sub_f32 v71, v71, v250
    v_sub_f32 v80, v80, v250
    v_sub_f32 v81, v81, v250
    v_sub_f32 v82, v82, v250
    v_sub_f32 v83, v83, v250
    v_sub_f32 v84, v84, v250
    v_sub_f32 v85, v85, v250
    v_sub_f32 v86, v86, v250
    v_sub_f32 v87, v87, v250
    v_sub_f32 v240, 0, v251
    v_sub_f32 v241, 0, v251
    v_sub_f32 v242, 0, v251
    v_sub_f32 v243, 0, v251
    v_sub_f32 v72, v72, v251
    v_sub_f32 v73, v73, v251
    v_sub_f32 v74, v74, v251
    v_sub_f32 v75, v75, v251
    v_sub_f32 v76, v76, v251
    v_sub_f32 v77, v77, v251
    v_sub_f32 v78, v78, v251
    v_sub_f32 v79, v79, v251
    v_sub_f32 v88, v88, v251
    v_sub_f32 v89, v89, v251
    v_sub_f32 v90, v90, v251
    v_sub_f32 v91, v91, v251
    v_sub_f32 v92, v92, v251
    v_sub_f32 v93, v93, v251
    v_sub_f32 v94, v94, v251
    v_sub_f32 v95, v95, v251
    s_waitcnt vmcnt(6)
L_attn:
    s_mov_b32 s60, 8
L_at:
    s_barrier
    ds_read_b128 v[160:163], v224 offset:0
    ds_read_b128 v[164:167], v225 offset:0
    ds_read_b128 v[168:171], v226 offset:0
    ds_read_b128 v[172:175], v227 offset:0
    ds_read_b128 v[176:179], v224 offset:4096
    ds_read_b128 v[180:183], v225 offset:4096
    ds_read_b128 v[184:187], v226 offset:4096
    ds_read_b128 v[188:191], v227 offset:4096
    s_mov_b32 s65, s64
    s_cmp_eq_u32 s63, 131072
    s_cselect_b32 s64, 0xfffe0000, s7
    s_add_u32 s63, s63, s64
    v_exp_f32 v64, v64
    v_exp_f32 v65, v65
    v_add_f32 v245, v245, v64
    v_exp_f32 v66, v66
    v_add_f32 v245, v245, v65
    v_exp_f32 v67, v67
    v_cvt_pk_bf16_f32 v64, v64, v65
    v_add_f32 v245, v245, v66
    v_exp_f32 v68, v68
    v_add_f32 v245, v245, v67
    v_exp_f32 v69, v69
    v_cvt_pk_bf16_f32 v65, v66, v67
    v_add_f32 v245, v245, v68
    v_exp_f32 v70, v70
    v_add_f32 v245, v245, v69
    v_exp_f32 v71, v71
    s_waitcnt lgkmcnt(7)
    v_mfma_f32_16x16x32_bf16 v[96:99], v[160:163], v[128:131], v[236:239]
    v_cvt_pk_bf16_f32 v66, v68, v69
    v_add_f32 v245, v245, v70
    v_mfma_f32_16x16x32_bf16 v[104:107], v[160:163], v[132:135], v[240:243]
    ds_read_b128 v[160:163], v224 offset:8192
    v_add_f32 v245, v245, v71
    v_cvt_pk_bf16_f32 v67, v70, v71
    s_waitcnt lgkmcnt(7)
    v_mfma_f32_16x16x32_bf16 v[104:107], v[164:167], v[140:143], v[104:107]
    v_exp_f32 v72, v72
    v_mfma_f32_16x16x32_bf16 v[96:99], v[164:167], v[136:139], v[96:99]
    ds_read_b128 v[164:167], v225 offset:8192
    v_exp_f32 v73, v73
    s_waitcnt lgkmcnt(7)
    v_mfma_f32_16x16x32_bf16 v[96:99], v[168:171], v[144:147], v[96:99]
    v_add_f32 v246, v246, v72
    v_mfma_f32_16x16x32_bf16 v[104:107], v[168:171], v[148:151], v[104:107]
    ds_read_b128 v[168:171], v226 offset:8192
    v_exp_f32 v74, v74
    s_waitcnt lgkmcnt(7)
    v_mfma_f32_16x16x32_bf16 v[104:107], v[172:175], v[156:159], v[104:107]
    v_add_f32 v246, v246, v73
    v_mfma_f32_16x16x32_bf16 v[96:99], v[172:175], v[152:155], v[96:99]
    ds_read_b128 v[172:175], v227 offset:8192
    v_exp_f32 v75, v75
    v_cvt_pk_bf16_f32 v72, v72, v73
    s_waitcnt lgkmcnt(7)
    v_mfma_f32_16x16x32_bf16 v[100:103], v[176:179], v[128:131], v[236:239]
    v_add_f32 v246, v246, v74
    v_mfma_f32_16x16x32_bf16 v[108:111], v[176:179], v[132:135], v[240:243]
    ds_read_b128 v[176:179], v224 offset:12288
    v_exp_f32 v76, v76
    s_waitcnt lgkmcnt(7)
    v_mfma_f32_16x16x32_bf16 v[108:111], v[180:183], v[140:143], v[108:111]
    v_add_f32 v246, v246, v75
    v_exp_f32 v77, v77
    v_mfma_f32_16x16x32_bf16 v[100:103], v[180:183], v[136:139], v[100:103]
    ds_read_b128 v[180:183], v225 offset:12288
    v_cvt_pk_bf16_f32 v73, v74, v75
    s_waitcnt lgkmcnt(7)
    v_mfma_f32_16x16x32_bf16 v[100:103], v[184:187], v[144:147], v[100:103]
    v_add_f32 v246, v246, v76
    v_mfma_f32_16x16x32_bf16 v[108:111], v[184:187], v[148:151], v[108:111]
    ds_read_b128 v[184:187], v226 offset:12288
    v_exp_f32 v78, v78
    v_add_f32 v246, v246, v77
    s_waitcnt lgkmcnt(7)
    v_mfma_f32_16x16x32_bf16 v[108:111], v[188:191], v[156:159], v[108:111]
    v_exp_f32 v79, v79
    v_mfma_f32_16x16x32_bf16 v[100:103], v[188:191], v[152:155], v[100:103]
    ds_read_b128 v[188:191], v227 offset:12288
    v_cvt_pk_bf16_f32 v74, v76, v77
    s_waitcnt lgkmcnt(7)
    v_mfma_f32_16x16x32_bf16 v[112:115], v[160:163], v[128:131], v[236:239]
    v_add_f32 v246, v246, v78
    v_add_f32 v246, v246, v79
    v_mfma_f32_16x16x32_bf16 v[120:123], v[160:163], v[132:135], v[240:243]
    v_cvt_pk_bf16_f32 v75, v78, v79
    s_waitcnt lgkmcnt(6)
    v_mfma_f32_16x16x32_bf16 v[120:123], v[164:167], v[140:143], v[120:123]
    v_exp_f32 v80, v80
    v_mfma_f32_16x16x32_bf16 v[112:115], v[164:167], v[136:139], v[112:115]
    v_exp_f32 v81, v81
    v_add_f32 v245, v245, v80
    s_waitcnt lgkmcnt(5)
    v_mfma_f32_16x16x32_bf16 v[112:115], v[168:171], v[144:147], v[112:115]
    v_exp_f32 v82, v82
    v_mfma_f32_16x16x32_bf16 v[120:123], v[168:171], v[148:151], v[120:123]
    ds_read_b64_tr_b16 v[192:193], v228 offset:0
    ds_read_b64_tr_b16 v[194:195], v228 offset:4096
    v_add_f32 v245, v245, v81
    s_waitcnt lgkmcnt(6)
    v_mfma_f32_16x16x32_bf16 v[120:123], v[172:175], v[156:159], v[120:123]
    v_exp_f32 v83, v83
    v_mfma_f32_16x16x32_bf16 v[112:115], v[172:175], v[152:155], v[112:115]
    ds_read_b64_tr_b16 v[196:197], v229 offset:0
    ds_read_b64_tr_b16 v[198:199], v229 offset:4096
    v_cvt_pk_bf16_f32 v80, v80, v81
    v_add_f32 v245, v245, v82
    s_waitcnt lgkmcnt(7)
    v_mfma_f32_16x16x32_bf16 v[116:119], v[176:179], v[128:131], v[236:239]
    v_exp_f32 v84, v84
    v_mfma_f32_16x16x32_bf16 v[124:127], v[176:179], v[132:135], v[240:243]
    ds_read_b64_tr_b16 v[200:201], v230 offset:0
    ds_read_b64_tr_b16 v[202:203], v230 offset:4096
    v_add_f32 v245, v245, v83
    s_waitcnt lgkmcnt(8)
    v_mfma_f32_16x16x32_bf16 v[124:127], v[180:183], v[140:143], v[124:127]
    v_exp_f32 v85, v85
    v_mfma_f32_16x16x32_bf16 v[116:119], v[180:183], v[136:139], v[116:119]
    ds_read_b64_tr_b16 v[204:205], v231 offset:0
    ds_read_b64_tr_b16 v[206:207], v231 offset:4096
    v_cvt_pk_bf16_f32 v81, v82, v83
    v_add_f32 v245, v245, v84
    s_waitcnt lgkmcnt(9)
    v_mfma_f32_16x16x32_bf16 v[116:119], v[184:187], v[144:147], v[116:119]
    v_exp_f32 v86, v86
    v_mfma_f32_16x16x32_bf16 v[124:127], v[184:187], v[148:151], v[124:127]
    ds_read_b64_tr_b16 v[208:209], v232 offset:0
    ds_read_b64_tr_b16 v[210:211], v232 offset:4096
    v_add_f32 v245, v245, v85
    s_waitcnt lgkmcnt(10)
    v_mfma_f32_16x16x32_bf16 v[124:127], v[188:191], v[156:159], v[124:127]
    v_exp_f32 v87, v87
    v_cvt_pk_bf16_f32 v82, v84, v85
    v_mfma_f32_16x16x32_bf16 v[116:119], v[188:191], v[152:155], v[116:119]
    ds_read_b64_tr_b16 v[212:213], v233 offset:0
    ds_read_b64_tr_b16 v[214:215], v233 offset:4096
    v_add_f32 v245, v245, v86
    v_add_f32 v245, v245, v87
    s_waitcnt lgkmcnt(10)
    v_mfma_f32_16x16x32_bf16 v[0:3], v[192:195], v[64:67], v[0:3]
    v_cvt_pk_bf16_f32 v83, v86, v87
    v_mfma_f32_16x16x32_bf16 v[4:7], v[192:195], v[72:75], v[4:7]
    ds_read_b64_tr_b16 v[192:193], v234 offset:0
    ds_read_b64_tr_b16 v[194:195], v234 offset:4096
    v_exp_f32 v88, v88
    s_waitcnt lgkmcnt(10)
    v_mfma_f32_16x16x32_bf16 v[8:11], v[196:199], v[64:67], v[8:11]
    v_exp_f32 v89, v89
    v_mfma_f32_16x16x32_bf16 v[12:15], v[196:199], v[72:75], v[12:15]
    ds_read_b64_tr_b16 v[196:197], v235 offset:0
    ds_read_b64_tr_b16 v[198:199], v235 offset:4096
    v_add_f32 v246, v246, v88
    v_add_u32 v224, s64, v224
    s_waitcnt lgkmcnt(10)
    v_mfma_f32_16x16x32_bf16 v[16:19], v[200:203], v[64:67], v[16:19]
    v_exp_f32 v90, v90
    v_add_f32 v246, v246, v89
    v_mfma_f32_16x16x32_bf16 v[20:23], v[200:203], v[72:75], v[20:23]
    ds_read_b64_tr_b16 v[200:201], v228 offset:8192
    ds_read_b64_tr_b16 v[202:203], v228 offset:12288
    v_exp_f32 v91, v91
    s_waitcnt lgkmcnt(10)
    v_mfma_f32_16x16x32_bf16 v[24:27], v[204:207], v[64:67], v[24:27]
    v_cvt_pk_bf16_f32 v88, v88, v89
    v_mfma_f32_16x16x32_bf16 v[28:31], v[204:207], v[72:75], v[28:31]
    ds_read_b64_tr_b16 v[204:205], v229 offset:8192
    ds_read_b64_tr_b16 v[206:207], v229 offset:12288
    v_add_f32 v246, v246, v90
    v_exp_f32 v92, v92
    v_add_u32 v225, s64, v225
    s_waitcnt lgkmcnt(10)
    v_mfma_f32_16x16x32_bf16 v[32:35], v[208:211], v[64:67], v[32:35]
    v_add_f32 v246, v246, v91
    v_mfma_f32_16x16x32_bf16 v[36:39], v[208:211], v[72:75], v[36:39]
    ds_read_b64_tr_b16 v[208:209], v230 offset:8192
    ds_read_b64_tr_b16 v[210:211], v230 offset:12288
    v_exp_f32 v93, v93
    s_waitcnt lgkmcnt(10)
    v_mfma_f32_16x16x32_bf16 v[40:43], v[212:215], v[64:67], v[40:43]
    v_cvt_pk_bf16_f32 v89, v90, v91
    v_add_f32 v246, v246, v92
    v_mfma_f32_16x16x32_bf16 v[44:47], v[212:215], v[72:75], v[44:47]
    ds_read_b64_tr_b16 v[212:213], v231 offset:8192
    ds_read_b64_tr_b16 v[214:215], v231 offset:12288
    v_exp_f32 v94, v94
    v_add_u32 v226, s64, v226
    s_waitcnt lgkmcnt(10)
    v_mfma_f32_16x16x32_bf16 v[48:51], v[192:195], v[64:67], v[48:51]
    v_add_f32 v246, v246, v93
    v_mfma_f32_16x16x32_bf16 v[52:55], v[192:195], v[72:75], v[52:55]
    ds_read_b64_tr_b16 v[192:193], v232 offset:8192
    ds_read_b64_tr_b16 v[194:195], v232 offset:12288
    v_exp_f32 v95, v95
    s_waitcnt lgkmcnt(10)
    v_mfma_f32_16x16x32_bf16 v[56:59], v[196:199], v[64:67], v[56:59]
    v_cvt_pk_bf16_f32 v90, v92, v93
    v_add_f32 v246, v246, v94
    v_mfma_f32_16x16x32_bf16 v[60:63], v[196:199], v[72:75], v[60:63]
    ds_read_b64_tr_b16 v[196:197], v233 offset:8192
    ds_read_b64_tr_b16 v[198:199], v233 offset:12288
    v_add_f32 v246, v246, v95
    v_cvt_pk_bf16_f32 v91, v94, v95
    v_add_u32 v227, s64, v227
    s_waitcnt lgkmcnt(10)
    v_mfma_f32_16x16x32_bf16 v[0:3], v[200:203], v[80:83], v[0:3]
    v_max3_f32 v247, v96, v97, v98
    v_max3_f32 v248, v104, v105, v106
    v_mfma_f32_16x16x32_bf16 v[4:7], v[200:203], v[88:91], v[4:7]
    ds_read_b64_tr_b16 v[200:201], v234 offset:8192
    ds_read_b64_tr_b16 v[202:203], v234 offset:12288
    s_waitcnt lgkmcnt(10)
    v_mfma_f32_16x16x32_bf16 v[8:11], v[204:207], v[80:83], v[8:11]
    v_max3_f32 v247, v247, v99, v100
    v_max3_f32 v248, v248, v107, v108
    v_mfma_f32_16x16x32_bf16 v[12:15], v[204:207], v[88:91], v[12:15]
    ds_read_b64_tr_b16 v[204:205], v235 offset:8192
    ds_read_b64_tr_b16 v[206:207], v235 offset:12288
    s_waitcnt lgkmcnt(10)
    v_mfma_f32_16x16x32_bf16 v[16:19], v[208:211], v[80:83], v[16:19]
    v_max3_f32 v247, v247, v101, v102
    v_max3_f32 v248, v248, v109, v110
    v_mfma_f32_16x16x32_bf16 v[20:23], v[208:211], v[88:91], v[20:23]
    v_max_f32 v247, v247, v103
    v_add_u32 v228, s65, v228
    s_waitcnt lgkmcnt(8)
    v_mfma_f32_16x16x32_bf16 v[24:27], v[212:215], v[80:83], v[24:27]
    v_max_f32 v248, v248, v111
    v_max3_f32 v247, v247, v112, v113
    v_mfma_f32_16x16x32_bf16 v[28:31], v[212:215], v[88:91], v[28:31]
    v_max3_f32 v248, v248, v120, v121
    v_add_u32 v229, s65, v229
    s_waitcnt lgkmcnt(6)
    v_mfma_f32_16x16x32_bf16 v[32:35], v[192:195], v[80:83], v[32:35]
    v_max3_f32 v247, v247, v114, v115
    v_max3_f32 v248, v248, v122, v123
    v_mfma_f32_16x16x32_bf16 v[36:39], v[192:195], v[88:91], v[36:39]
    v_max3_f32 v247, v247, v116, v117
    v_add_u32 v230, s65, v230
    s_waitcnt lgkmcnt(4)
    v_mfma_f32_16x16x32_bf16 v[40:43], v[196:199], v[80:83], v[40:43]
    v_max3_f32 v248, v248, v124, v125
    v_max3_f32 v247, v247, v118, v119
    v_mfma_f32_16x16x32_bf16 v[44:47], v[196:199], v[88:91], v[44:47]
    v_max3_f32 v248, v248, v126, v127
    v_add_u32 v231, s65, v231
    s_waitcnt lgkmcnt(2)
    v_mfma_f32_16x16x32_bf16 v[48:51], v[200:203], v[80:83], v[48:51]
    v_max_f32 v250, v247, v248
    v_cmp_lt_f32 vcc, s62, v250
    v_mfma_f32_16x16x32_bf16 v[52:55], v[200:203], v[88:91], v[52:55]
    v_add_u32 v232, s65, v232
    s_waitcnt lgkmcnt(0)
    v_mfma_f32_16x16x32_bf16 v[56:59], v[204:207], v[80:83], v[56:59]
    v_add_u32 v233, s65, v233
    v_add_u32 v234, s65, v234
    v_mfma_f32_16x16x32_bf16 v[60:63], v[204:207], v[88:91], v[60:63]
    v_add_u32 v235, s65, v235
    s_cbranch_vccnz L_resc_a
L_back_a:
    s_cmp_lt_u32 s60, 8
    s_cbranch_scc1 L_nw
    s_waitcnt vmcnt(0)
L_nw:
    s_sub_u32 s60, s60, 1
    s_cmp_eq_u32 s60, 0
    s_cbranch_scc1 L_last
L_even:
    s_barrier
    ds_read_b128 v[160:163], v224 offset:0
    ds_read_b128 v[164:167], v225 offset:0
    ds_read_b128 v[168:171], v226 offset:0
    ds_read_b128 v[172:175], v227 offset:0
    ds_read_b128 v[176:179], v224 offset:4096
    ds_read_b128 v[180:183], v225 offset:4096
    ds_read_b128 v[184:187], v226 offset:4096
    ds_read_b128 v[188:191], v227 offset:4096
    s_mov_b32 s65, s64
    s_cmp_eq_u32 s63, 131072
    s_cselect_b32 s64, 0xfffe0000, s7
    s_add_u32 s63, s63, s64
    v_exp_f32 v96, v96
    v_exp_f32 v97, v97
    v_add_f32 v245, v245, v96
    v_exp_f32 v98, v98
    v_add_f32 v245, v245, v97
    v_exp_f32 v99, v99
    v_cvt_pk_bf16_f32 v96, v96, v97
    v_add_f32 v245, v245, v98
    v_exp_f32 v100, v100
    v_add_f32 v245, v245, v99
    v_exp_f32 v101, v101
    v_cvt_pk_bf16_f32 v97, v98, v99
    v_add_f32 v245, v245, v100
    v_exp_f32 v102, v102
    v_add_f32 v245, v245, v101
    v_exp_f32 v103, v103
    s_waitcnt lgkmcnt(7)
    v_mfma_f32_16x16x32_bf16 v[64:67], v[160:163], v[128:131], v[236:239]
    v_cvt_pk_bf16_f32 v98, v100, v101
    v_add_f32 v245, v245, v102
    v_mfma_f32_16x16x32_bf16 v[72:75], v[160:163], v[132:135], v[240:243]
    ds_read_b128 v[160:163], v224 offset:8192
    v_add_f32 v245, v245, v103
    v_cvt_pk_bf16_f32 v99, v102, v103
    s_waitcnt lgkmcnt(7)
    v_mfma_f32_16x16x32_bf16 v[72:75], v[164:167], v[140:143], v[72:75]
    v_exp_f32 v104, v104
    v_mfma_f32_16x16x32_bf16 v[64:67], v[164:167], v[136:139], v[64:67]
    ds_read_b128 v[164:167], v225 offset:8192
    v_exp_f32 v105, v105
    s_waitcnt lgkmcnt(7)
    v_mfma_f32_16x16x32_bf16 v[64:67], v[168:171], v[144:147], v[64:67]
    v_add_f32 v246, v246, v104
    v_mfma_f32_16x16x32_bf16 v[72:75], v[168:171], v[148:151], v[72:75]
    ds_read_b128 v[168:171], v226 offset:8192
    v_exp_f32 v106, v106
    s_waitcnt lgkmcnt(7)
    v_mfma_f32_16x16x32_bf16 v[72:75], v[172:175], v[156:159], v[72:75]
    v_add_f32 v246, v246, v105
    v_mfma_f32_16x16x32_bf16 v[64:67], v[172:175], v[152:155], v[64:67]
    ds_read_b128 v[172:175], v227 offset:8192
    v_exp_f32 v107, v107
    v_cvt_pk_bf16_f32 v104, v104, v105
    s_waitcnt lgkmcnt(7)
    v_mfma_f32_16x16x32_bf16 v[68:71], v[176:179], v[128:131], v[236:239]
    v_add_f32 v246, v246, v106
    v_mfma_f32_16x16x32_bf16 v[76:79], v[176:179], v[132:135], v[240:243]
    ds_read_b128 v[176:179], v224 offset:12288
    v_exp_f32 v108, v108
    s_waitcnt lgkmcnt(7)
    v_mfma_f32_16x16x32_bf16 v[76:79], v[180:183], v[140:143], v[76:79]
    v_add_f32 v246, v246, v107
    v_exp_f32 v109, v109
    v_mfma_f32_16x16x32_bf16 v[68:71], v[180:183], v[136:139], v[68:71]
    ds_read_b128 v[180:183], v225 offset:12288
    v_cvt_pk_bf16_f32 v105, v106, v107
    s_waitcnt lgkmcnt(7)
    v_mfma_f32_16x16x32_bf16 v[68:71], v[184:187], v[144:147], v[68:71]
    v_add_f32 v246, v246, v108
    v_mfma_f32_16x16x32_bf16 v[76:79], v[184:187], v[148:151], v[76:79]
    ds_read_b128 v[184:187], v226 offset:12288
    v_exp_f32 v110, v110
    v_add_f32 v246, v246, v109
    s_waitcnt lgkmcnt(7)
    v_mfma_f32_16x16x32_bf16 v[76:79], v[188:191], v[156:159], v[76:79]
    v_exp_f32 v111, v111
    v_mfma_f32_16x16x32_bf16 v[68:71], v[188:191], v[152:155], v[68:71]
    ds_read_b128 v[188:191], v227 offset:12288
    v_cvt_pk_bf16_f32 v106, v108, v109
    s_waitcnt lgkmcnt(7)
    v_mfma_f32_16x16x32_bf16 v[80:83], v[160:163], v[128:131], v[236:239]
    v_add_f32 v246, v246, v110
    v_add_f32 v246, v246, v111
    v_mfma_f32_16x16x32_bf16 v[88:91], v[160:163], v[132:135], v[240:243]
    v_cvt_pk_bf16_f32 v107, v110, v111
    s_waitcnt lgkmcnt(6)
    v_mfma_f32_16x16x32_bf16 v[88:91], v[164:167], v[140:143], v[88:91]
    v_exp_f32 v112, v112
    v_mfma_f32_16x16x32_bf16 v[80:83], v[164:167], v[136:139], v[80:83]
    v_exp_f32 v113, v113
    v_add_f32 v245, v245, v112
    s_waitcnt lgkmcnt(5)
    v_mfma_f32_16x16x32_bf16 v[80:83], v[168:171], v[144:147], v[80:83]
    v_exp_f32 v114, v114
    v_mfma_f32_16x16x32_bf16 v[88:91], v[168:171], v[148:151], v[88:91]
    ds_read_b64_tr_b16 v[192:193], v228 offset:0
    ds_read_b64_tr_b16 v[194:195], v228 offset:4096
    v_add_f32 v245, v245, v113
    s_waitcnt lgkmcnt(6)
    v_mfma_f32_16x16x32_bf16 v[88:91], v[172:175], v[156:159], v[88:91]
    v_exp_f32 v115, v115
    v_mfma_f32_16x16x32_bf16 v[80:83], v[172:175], v[152:155], v[80:83]
    ds_read_b64_tr_b16 v[196:197], v229 offset:0
    ds_read_b64_tr_b16 v[198:199], v229 offset:4096
    v_cvt_pk_bf16_f32 v112, v112, v113
    v_add_f32 v245, v245, v114
    s_waitcnt lgkmcnt(7)
    v_mfma_f32_16x16x32_bf16 v[84:87], v[176:179], v[128:131], v[236:239]
    v_exp_f32 v116, v116
    v_mfma_f32_16x16x32_bf16 v[92:95], v[176:179], v[132:135], v[240:243]
    ds_read_b64_tr_b16 v[200:201], v230 offset:0
    ds_read_b64_tr_b16 v[202:203], v230 offset:4096
    v_add_f32 v245, v245, v115
    s_waitcnt lgkmcnt(8)
    v_mfma_f32_16x16x32_bf16 v[92:95], v[180:183], v[140:143], v[92:95]
    v_exp_f32 v117, v117
    v_mfma_f32_16x16x32_bf16 v[84:87], v[180:183], v[136:139], v[84:87]
    ds_read_b64_tr_b16 v[204:205], v231 offset:0
    ds_read_b64_tr_b16 v[206:207], v231 offset:4096
    v_cvt_pk_bf16_f32 v113, v114, v115
    v_add_f32 v245, v245, v116
    s_waitcnt lgkmcnt(9)
    v_mfma_f32_16x16x32_bf16 v[84:87], v[184:187], v[144:147], v[84:87]
    v_exp_f32 v118, v118
    v_mfma_f32_16x16x32_bf16 v[92:95], v[184:187], v[148:151], v[92:95]
    ds_read_b64_tr_b16 v[208:209], v232 offset:0
    ds_read_b64_tr_b16 v[210:211], v232 offset:4096
    v_add_f32 v245, v245, v117
    s_waitcnt lgkmcnt(10)
    v_mfma_f32_16x16x32_bf16 v[92:95], v[188:191], v[156:159], v[92:95]
    v_exp_f32 v119, v119
    v_cvt_pk_bf16_f32 v114, v116, v117
    v_mfma_f32_16x16x32_bf16 v[84:87], v[188:191], v[152:155], v[84:87]
    ds_read_b64_tr_b16 v[212:213], v233 offset:0
    ds_read_b64_tr_b16 v[214:215], v233 offset:4096
    v_add_f32 v245, v245, v118
    v_add_f32 v245, v245, v119
    s_waitcnt lgkmcnt(10)
    v_mfma_f32_16x16x32_bf16 v[0:3], v[192:195], v[96:99], v[0:3]
    v_cvt_pk_bf16_f32 v115, v118, v119
    v_mfma_f32_16x16x32_bf16 v[4:7], v[192:195], v[104:107], v[4:7]
    ds_read_b64_tr_b16 v[192:193], v234 offset:0
    ds_read_b64_tr_b16 v[194:195], v234 offset:4096
    v_exp_f32 v120, v120
    s_waitcnt lgkmcnt(10)
    v_mfma_f32_16x16x32_bf16 v[8:11], v[196:199], v[96:99], v[8:11]
    v_exp_f32 v121, v121
    v_mfma_f32_16x16x32_bf16 v[12:15], v[196:199], v[104:107], v[12:15]
    ds_read_b64_tr_b16 v[196:197], v235 offset:0
    ds_read_b64_tr_b16 v[198:199], v235 offset:4096
    v_add_f32 v246, v246, v120
    v_add_u32 v224, s64, v224
    s_waitcnt lgkmcnt(10)
    v_mfma_f32_16x16x32_bf16 v[16:19], v[200:203], v[96:99], v[16:19]
    v_exp_f32 v122, v122
    v_add_f32 v246, v246, v121
    v_mfma_f32_16x16x32_bf16 v[20:23], v[200:203], v[104:107], v[20:23]
    ds_read_b64_tr_b16 v[200:201], v228 offset:8192
    ds_read_b64_tr_b16 v[202:203], v228 offset:12288
    v_exp_f32 v123, v123
    s_waitcnt lgkmcnt(10)
    v_mfma_f32_16x16x32_bf16 v[24:27], v[204:207], v[96:99], v[24:27]
    v_cvt_pk_bf16_f32 v120, v120, v121
    v_mfma_f32_16x16x32_bf16 v[28:31], v[204:207], v[104:107], v[28:31]
    ds_read_b64_tr_b16 v[204:205], v229 offset:8192
    ds_read_b64_tr_b16 v[206:207], v229 offset:12288
    v_add_f32 v246, v246, v122
    v_exp_f32 v124, v124
    v_add_u32 v225, s64, v225
    s_waitcnt lgkmcnt(10)
    v_mfma_f32_16x16x32_bf16 v[32:35], v[208:211], v[96:99], v[32:35]
    v_add_f32 v246, v246, v123
    v_mfma_f32_16x16x32_bf16 v[36:39], v[208:211], v[104:107], v[36:39]
    ds_read_b64_tr_b16 v[208:209], v230 offset:8192
    ds_read_b64_tr_b16 v[210:211], v230 offset:12288
    v_exp_f32 v125, v125
    s_waitcnt lgkmcnt(10)
    v_mfma_f32_16x16x32_bf16 v[40:43], v[212:215], v[96:99], v[40:43]
    v_cvt_pk_bf16_f32 v121, v122, v123
    v_add_f32 v246, v246, v124
    v_mfma_f32_16x16x32_bf16 v[44:47], v[212:215], v[104:107], v[44:47]
    ds_read_b64_tr_b16 v[212:213], v231 offset:8192
    ds_read_b64_tr_b16 v[214:215], v231 offset:12288
    v_exp_f32 v126, v126
    v_add_u32 v226, s64, v226
    s_waitcnt lgkmcnt(10)
    v_mfma_f32_16x16x32_bf16 v[48:51], v[192:195], v[96:99], v[48:51]
    v_add_f32 v246, v246, v125
    v_mfma_f32_16x16x32_bf16 v[52:55], v[192:195], v[104:107], v[52:55]
    ds_read_b64_tr_b16 v[192:193], v232 offset:8192
    ds_read_b64_tr_b16 v[194:195], v232 offset:12288
    v_exp_f32 v127, v127
    s_waitcnt lgkmcnt(10)
    v_mfma_f32_16x16x32_bf16 v[56:59], v[196:199], v[96:99], v[56:59]
    v_cvt_pk_bf16_f32 v122, v124, v125
    v_add_f32 v246, v246, v126
    v_mfma_f32_16x16x32_bf16 v[60:63], v[196:199], v[104:107], v[60:63]
    ds_read_b64_tr_b16 v[196:197], v233 offset:8192
    ds_read_b64_tr_b16 v[198:199], v233 offset:12288
    v_add_f32 v246, v246, v127
    v_cvt_pk_bf16_f32 v123, v126, v127
    v_add_u32 v227, s64, v227
    s_waitcnt lgkmcnt(10)
    v_mfma_f32_16x16x32_bf16 v[0:3], v[200:203], v[112:115], v[0:3]
    v_max3_f32 v247, v64, v65, v66
    v_max3_f32 v248, v72, v73, v74
    v_mfma_f32_16x16x32_bf16 v[4:7], v[200:203], v[120:123], v[4:7]
    ds_read_b64_tr_b16 v[200:201], v234 offset:8192
    ds_read_b64_tr_b16 v[202:203], v234 offset:12288
    s_waitcnt lgkmcnt(10)
    v_mfma_f32_16x16x32_bf16 v[8:11], v[204:207], v[112:115], v[8:11]
    v_max3_f32 v247, v247, v67, v68
    v_max3_f32 v248, v248, v75, v76
    v_mfma_f32_16x16x32_bf16 v[12:15], v[204:207], v[120:123], v[12:15]
    ds_read_b64_tr_b16 v[204:205], v235 offset:8192
    ds_read_b64_tr_b16 v[206:207], v235 offset:12288
    s_waitcnt lgkmcnt(10)
    v_mfma_f32_16x16x32_bf16 v[16:19], v[208:211], v[112:115], v[16:19]
    v_max3_f32 v247, v247, v69, v70
    v_max3_f32 v248, v248, v77, v78
    v_mfma_f32_16x16x32_bf16 v[20:23], v[208:211], v[120:123], v[20:23]
    v_max_f32 v247, v247, v71
    v_add_u32 v228, s65, v228
    s_waitcnt lgkmcnt(8)
    v_mfma_f32_16x16x32_bf16 v[24:27], v[212:215], v[112:115], v[24:27]
    v_max_f32 v248, v248, v79
    v_max3_f32 v247, v247, v80, v81
    v_mfma_f32_16x16x32_bf16 v[28:31], v[212:215], v[120:123], v[28:31]
    v_max3_f32 v248, v248, v88, v89
    v_add_u32 v229, s65, v229
    s_waitcnt lgkmcnt(6)
    v_mfma_f32_16x16x32_bf16 v[32:35], v[192:195], v[112:115], v[32:35]
    v_max3_f32 v247, v247, v82, v83
    v_max3_f32 v248, v248, v90, v91
    v_mfma_f32_16x16x32_bf16 v[36:39], v[192:195], v[120:123], v[36:39]
    v_max3_f32 v247, v247, v84, v85
    v_add_u32 v230, s65, v230
    s_waitcnt lgkmcnt(4)
    v_mfma_f32_16x16x32_bf16 v[40:43], v[196:199], v[112:115], v[40:43]
    v_max3_f32 v248, v248, v92, v93
    v_max3_f32 v247, v247, v86, v87
    v_mfma_f32_16x16x32_bf16 v[44:47], v[196:199], v[120:123], v[44:47]
    v_max3_f32 v248, v248, v94, v95
    v_add_u32 v231, s65, v231
    s_waitcnt lgkmcnt(2)
    v_mfma_f32_16x16x32_bf16 v[48:51], v[200:203], v[112:115], v[48:51]
    v_max_f32 v250, v247, v248
    v_cmp_lt_f32 vcc, s62, v250
    v_mfma_f32_16x16x32_bf16 v[52:55], v[200:203], v[120:123], v[52:55]
    v_add_u32 v232, s65, v232
    s_waitcnt lgkmcnt(0)
    v_mfma_f32_16x16x32_bf16 v[56:59], v[204:207], v[112:115], v[56:59]
    v_add_u32 v233, s65, v233
    v_add_u32 v234, s65, v234
    v_mfma_f32_16x16x32_bf16 v[60:63], v[204:207], v[120:123], v[60:63]
    v_add_u32 v235, s65, v235
    s_cbranch_vccnz L_resc_b
L_back_b:
    s_lshl_b32 s66, s33, 4
    s_add_u32 s66, s66, s60
    s_cmp_lg_u32 s66, 7
    s_cbranch_scc1 L_at
    s_mov_b64 exec, 1
    s_and_b32 s66, s2, 63
    s_lshl_b32 s66, s66, 2
    v_mov_b32 v250, s66
    v_mov_b32 v251, 1
    global_atomic_add v250, v251, s[48:49] sc1
    s_mov_b64 exec, -1
    s_branch L_at
L_last:
    s_cmp_lg_u32 s4, 0
    s_cbranch_scc1 L_nb
    s_barrier
L_nb:
    ds_read_b64_tr_b16 v[192:193], v228 offset:0
    ds_read_b64_tr_b16 v[194:195], v228 offset:4096
    ds_read_b64_tr_b16 v[196:197], v229 offset:0
    ds_read_b64_tr_b16 v[198:199], v229 offset:4096
    ds_read_b64_tr_b16 v[200:201], v230 offset:0
    ds_read_b64_tr_b16 v[202:203], v230 offset:4096
    ds_read_b64_tr_b16 v[204:205], v231 offset:0
    ds_read_b64_tr_b16 v[206:207], v231 offset:4096
    ds_read_b64_tr_b16 v[208:209], v232 offset:0
    ds_read_b64_tr_b16 v[210:211], v232 offset:4096
    ds_read_b64_tr_b16 v[212:213], v233 offset:0
    ds_read_b64_tr_b16 v[214:215], v233 offset:4096
    v_exp_f32 v96, v96
    v_exp_f32 v97, v97
    v_add_f32 v245, v245, v96
    v_exp_f32 v98, v98
    v_add_f32 v245, v245, v97
    v_exp_f32 v99, v99
    v_cvt_pk_bf16_f32 v96, v96, v97
    v_add_f32 v245, v245, v98
    v_exp_f32 v100, v100
    v_add_f32 v245, v245, v99
    v_exp_f32 v101, v101
    v_cvt_pk_bf16_f32 v97, v98, v99
    v_add_f32 v245, v245, v100
    v_exp_f32 v102, v102
    v_add_f32 v245, v245, v101
    v_exp_f32 v103, v103
    v_cvt_pk_bf16_f32 v98, v100, v101
    v_add_f32 v245, v245, v102
    v_add_f32 v245, v245, v103
    v_cvt_pk_bf16_f32 v99, v102, v103
    v_exp_f32 v104, v104
    v_exp_f32 v105, v105
    v_add_f32 v246, v246, v104
    v_exp_f32 v106, v106
    v_add_f32 v246, v246, v105
    v_exp_f32 v107, v107
    v_cvt_pk_bf16_f32 v104, v104, v105
    v_add_f32 v246, v246, v106
    v_exp_f32 v108, v108
    v_add_f32 v246, v246, v107
    v_exp_f32 v109, v109
    v_cvt_pk_bf16_f32 v105, v106, v107
    v_add_f32 v246, v246, v108
    v_exp_f32 v110, v110
    v_add_f32 v246, v246, v109
    v_exp_f32 v111, v111
    v_cvt_pk_bf16_f32 v106, v108, v109
    v_add_f32 v246, v246, v110
    v_add_f32 v246, v246, v111
    v_cvt_pk_bf16_f32 v107, v110, v111
    s_waitcnt lgkmcnt(10)
    v_mfma_f32_16x16x32_bf16 v[0:3], v[192:195], v[96:99], v[0:3]
    v_exp_f32 v112, v112
    v_exp_f32 v113, v113
    v_mfma_f32_16x16x32_bf16 v[4:7], v[192:195], v[104:107], v[4:7]
    ds_read_b64_tr_b16 v[192:193], v234 offset:0
    ds_read_b64_tr_b16 v[194:195], v234 offset:4096
    v_add_f32 v245, v245, v112
    v_exp_f32 v114, v114
    s_waitcnt lgkmcnt(10)
    v_mfma_f32_16x16x32_bf16 v[8:11], v[196:199], v[96:99], v[8:11]
    v_add_f32 v245, v245, v113
    v_exp_f32 v115, v115
    v_cvt_pk_bf16_f32 v112, v112, v113
    v_mfma_f32_16x16x32_bf16 v[12:15], v[196:199], v[104:107], v[12:15]
    ds_read_b64_tr_b16 v[196:197], v235 offset:0
    ds_read_b64_tr_b16 v[198:199], v235 offset:4096
    v_add_f32 v245, v245, v114
    v_exp_f32 v116, v116
    s_waitcnt lgkmcnt(10)
    v_mfma_f32_16x16x32_bf16 v[16:19], v[200:203], v[96:99], v[16:19]
    v_add_f32 v245, v245, v115
    v_exp_f32 v117, v117
    v_cvt_pk_bf16_f32 v113, v114, v115
    v_mfma_f32_16x16x32_bf16 v[20:23], v[200:203], v[104:107], v[20:23]
    ds_read_b64_tr_b16 v[200:201], v228 offset:8192
    ds_read_b64_tr_b16 v[202:203], v228 offset:12288
    v_add_f32 v245, v245, v116
    v_exp_f32 v118, v118
    s_waitcnt lgkmcnt(10)
    v_mfma_f32_16x16x32_bf16 v[24:27], v[204:207], v[96:99], v[24:27]
    v_add_f32 v245, v245, v117
    v_exp_f32 v119, v119
    v_cvt_pk_bf16_f32 v114, v116, v117
    v_mfma_f32_16x16x32_bf16 v[28:31], v[204:207], v[104:107], v[28:31]
    ds_read_b64_tr_b16 v[204:205], v229 offset:8192
    ds_read_b64_tr_b16 v[206:207], v229 offset:12288
    v_add_f32 v245, v245, v118
    v_add_f32 v245, v245, v119
    v_cvt_pk_bf16_f32 v115, v118, v119
    s_waitcnt lgkmcnt(10)
    v_mfma_f32_16x16x32_bf16 v[32:35], v[208:211], v[96:99], v[32:35]
    v_exp_f32 v120, v120
    v_exp_f32 v121, v121
    v_mfma_f32_16x16x32_bf16 v[36:39], v[208:211], v[104:107], v[36:39]
    ds_read_b64_tr_b16 v[208:209], v230 offset:8192
    ds_read_b64_tr_b16 v[210:211], v230 offset:12288
    v_add_f32 v246, v246, v120
    v_exp_f32 v122, v122
    s_waitcnt lgkmcnt(10)
    v_mfma_f32_16x16x32_bf16 v[40:43], v[212:215], v[96:99], v[40:43]
    v_add_f32 v246, v246, v121
    v_exp_f32 v123, v123
    v_cvt_pk_bf16_f32 v120, v120, v121
    v_mfma_f32_16x16x32_bf16 v[44:47], v[212:215], v[104:107], v[44:47]
    ds_read_b64_tr_b16 v[212:213], v231 offset:8192
    ds_read_b64_tr_b16 v[214:215], v231 offset:12288
    v_add_f32 v246, v246, v122
    v_exp_f32 v124, v124
    s_waitcnt lgkmcnt(10)
    v_mfma_f32_16x16x32_bf16 v[48:51], v[192:195], v[96:99], v[48:51]
    v_add_f32 v246, v246, v123
    v_exp_f32 v125, v125
    v_cvt_pk_bf16_f32 v121, v122, v123
    v_mfma_f32_16x16x32_bf16 v[52:55], v[192:195], v[104:107], v[52:55]
    ds_read_b64_tr_b16 v[192:193], v232 offset:8192
    ds_read_b64_tr_b16 v[194:195], v232 offset:12288
    v_add_f32 v246, v246, v124
    v_exp_f32 v126, v126
    s_waitcnt lgkmcnt(10)
    v_mfma_f32_16x16x32_bf16 v[56:59], v[196:199], v[96:99], v[56:59]
    v_add_f32 v246, v246, v125
    v_exp_f32 v127, v127
    v_cvt_pk_bf16_f32 v122, v124, v125
    v_mfma_f32_16x16x32_bf16 v[60:63], v[196:199], v[104:107], v[60:63]
    ds_read_b64_tr_b16 v[196:197], v233 offset:8192
    ds_read_b64_tr_b16 v[198:199], v233 offset:12288
    v_add_f32 v246, v246, v126
    v_add_f32 v246, v246, v127
    v_cvt_pk_bf16_f32 v123, v126, v127
    s_waitcnt lgkmcnt(10)
    v_mfma_f32_16x16x32_bf16 v[0:3], v[200:203], v[112:115], v[0:3]
    v_mfma_f32_16x16x32_bf16 v[4:7], v[200:203], v[120:123], v[4:7]
    ds_read_b64_tr_b16 v[200:201], v234 offset:8192
    ds_read_b64_tr_b16 v[202:203], v234 offset:12288
    s_waitcnt lgkmcnt(10)
    v_mfma_f32_16x16x32_bf16 v[8:11], v[204:207], v[112:115], v[8:11]
    v_mfma_f32_16x16x32_bf16 v[12:15], v[204:207], v[120:123], v[12:15]
    ds_read_b64_tr_b16 v[204:205], v235 offset:8192
    ds_read_b64_tr_b16 v[206:207], v235 offset:12288
    s_waitcnt lgkmcnt(10)
    v_mfma_f32_16x16x32_bf16 v[16:19], v[208:211], v[112:115], v[16:19]
    v_mfma_f32_16x16x32_bf16 v[20:23], v[208:211], v[120:123], v[20:23]
    s_waitcnt lgkmcnt(8)
    v_mfma_f32_16x16x32_bf16 v[24:27], v[212:215], v[112:115], v[24:27]
    v_mfma_f32_16x16x32_bf16 v[28:31], v[212:215], v[120:123], v[28:31]
    s_waitcnt lgkmcnt(6)
    v_mfma_f32_16x16x32_bf16 v[32:35], v[192:195], v[112:115], v[32:35]
    v_mfma_f32_16x16x32_bf16 v[36:39], v[192:195], v[120:123], v[36:39]
    s_waitcnt lgkmcnt(4)
    v_mfma_f32_16x16x32_bf16 v[40:43], v[196:199], v[112:115], v[40:43]
    v_mfma_f32_16x16x32_bf16 v[44:47], v[196:199], v[120:123], v[44:47]
    s_waitcnt lgkmcnt(2)
    v_mfma_f32_16x16x32_bf16 v[48:51], v[200:203], v[112:115], v[48:51]
    v_mfma_f32_16x16x32_bf16 v[52:55], v[200:203], v[120:123], v[52:55]
    s_waitcnt lgkmcnt(0)
    v_mfma_f32_16x16x32_bf16 v[56:59], v[204:207], v[112:115], v[56:59]
    v_mfma_f32_16x16x32_bf16 v[60:63], v[204:207], v[120:123], v[60:63]
    s_cmp_lg_u32 s4, 0
    s_cbranch_scc1 L_g1e
    s_setprio 2
    s_add_u32 s54, s68, 131072
    s_add_u32 s52, s52, 311296
    s_barrier
    s_add_u32 s54, s54, 32768
    s_add_u32 s66, s68, 163840
    s_cmp_eq_u32 s54, s66
    s_cselect_b32 s54, s68, s54
    s_add_u32 s55, s54, 16384
    s_add_u32 s52, s52, 16384
    s_mov_b32 m0, s54
    s_nop 0
    buffer_load_dwordx4 v216, s[8:11], s52 offen offset:0 nt lds
    buffer_load_dwordx4 v217, s[8:11], s52 offen offset:1024 nt lds
    buffer_load_dwordx4 v218, s[8:11], s52 offen offset:2048 nt lds
    buffer_load_dwordx4 v219, s[8:11], s52 offen offset:3072 nt lds
    s_mov_b32 m0, s55
    s_nop 0
    buffer_load_dwordx4 v220, s[12:15], s52 offen offset:0 nt lds
    buffer_load_dwordx4 v221, s[12:15], s52 offen offset:1024 nt lds
    buffer_load_dwordx4 v220, s[12:15], s52 offen offset:2048 nt lds
    buffer_load_dwordx4 v221, s[12:15], s52 offen offset:3072 nt lds
    v_and_b32 v248, 63, v249
    v_lshlrev_b32 v248, 2, v248
    global_load_dword v252, v248, s[48:49] sc1
    s_nop 0
    v_permlane32_swap_b32 v245, v246
    v_add_f32 v245, v245, v246
    v_mov_b32 v246, v245
    v_lshlrev_b32 v247, 4, v249
    s_nop 0
    v_permlane16_swap_b32 v245, v246
    v_add_f32 v245, v245, v246
    v_rcp_f32 v245, v245
    s_nop 0
    v_mov_b32 v250, v245
    v_mov_b32 v251, v245
    s_nop 1
    v_permlane32_swap_b32 v250, v251
    v_mul_f32 v0, v0, v250
    v_mul_f32 v1, v1, v250
    v_mul_f32 v2, v2, v250
    v_mul_f32 v3, v3, v250
    v_cvt_pk_bf16_f32 v64, v0, v1
    v_cvt_pk_bf16_f32 v65, v2, v3
    v_mul_f32 v8, v8, v250
    v_mul_f32 v9, v9, v250
    v_mul_f32 v10, v10, v250
    v_mul_f32 v11, v11, v250
    v_cvt_pk_bf16_f32 v66, v8, v9
    v_cvt_pk_bf16_f32 v67, v10, v11
    v_mul_f32 v4, v4, v251
    v_mul_f32 v5, v5, v251
    v_mul_f32 v6, v6, v251
    v_mul_f32 v7, v7, v251
    v_cvt_pk_bf16_f32 v68, v4, v5
    v_cvt_pk_bf16_f32 v69, v6, v7
    v_mul_f32 v12, v12, v251
    v_mul_f32 v13, v13, v251
    v_mul_f32 v14, v14, v251
    v_mul_f32 v15, v15, v251
    v_cvt_pk_bf16_f32 v70, v12, v13
    v_cvt_pk_bf16_f32 v71, v14, v15
    v_mul_f32 v16, v16, v250
    v_mul_f32 v17, v17, v250
    v_mul_f32 v18, v18, v250
    v_mul_f32 v19, v19, v250
    v_cvt_pk_bf16_f32 v72, v16, v17
    v_cvt_pk_bf16_f32 v73, v18, v19
    v_mul_f32 v24, v24, v250
    v_mul_f32 v25, v25, v250
    v_mul_f32 v26, v26, v250
    v_mul_f32 v27, v27, v250
    v_cvt_pk_bf16_f32 v74, v24, v25
    v_cvt_pk_bf16_f32 v75, v26, v27
    v_mul_f32 v20, v20, v251
    v_mul_f32 v21, v21, v251
    v_mul_f32 v22, v22, v251
    v_mul_f32 v23, v23, v251
    v_cvt_pk_bf16_f32 v76, v20, v21
    v_cvt_pk_bf16_f32 v77, v22, v23
    v_mul_f32 v28, v28, v251
    v_mul_f32 v29, v29, v251
    v_mul_f32 v30, v30, v251
    v_mul_f32 v31, v31, v251
    v_cvt_pk_bf16_f32 v78, v28, v29
    v_cvt_pk_bf16_f32 v79, v30, v31
    v_mul_f32 v32, v32, v250
    v_mul_f32 v33, v33, v250
    v_mul_f32 v34, v34, v250
    v_mul_f32 v35, v35, v250
    v_cvt_pk_bf16_f32 v80, v32, v33
    v_cvt_pk_bf16_f32 v81, v34, v35
    v_mul_f32 v40, v40, v250
    v_mul_f32 v41, v41, v250
    v_mul_f32 v42, v42, v250
    v_mul_f32 v43, v43, v250
    v_cvt_pk_bf16_f32 v82, v40, v41
    v_cvt_pk_bf16_f32 v83, v42, v43
    v_mul_f32 v36, v36, v251
    v_mul_f32 v37, v37, v251
    v_mul_f32 v38, v38, v251
    v_mul_f32 v39, v39, v251
    v_cvt_pk_bf16_f32 v84, v36, v37
    v_cvt_pk_bf16_f32 v85, v38, v39
    v_mul_f32 v44, v44, v251
    v_mul_f32 v45, v45, v251
    v_mul_f32 v46, v46, v251
    v_mul_f32 v47, v47, v251
    v_cvt_pk_bf16_f32 v86, v44, v45
    v_cvt_pk_bf16_f32 v87, v46, v47
    v_mul_f32 v48, v48, v250
    v_mul_f32 v49, v49, v250
    v_mul_f32 v50, v50, v250
    v_mul_f32 v51, v51, v250
    v_cvt_pk_bf16_f32 v88, v48, v49
    v_cvt_pk_bf16_f32 v89, v50, v51
    v_mul_f32 v56, v56, v250
    v_mul_f32 v57, v57, v250
    v_mul_f32 v58, v58, v250
    v_mul_f32 v59, v59, v250
    v_cvt_pk_bf16_f32 v90, v56, v57
    v_cvt_pk_bf16_f32 v91, v58, v59
    v_mul_f32 v52, v52, v251
    v_mul_f32 v53, v53, v251
    v_mul_f32 v54, v54, v251
    v_mul_f32 v55, v55, v251
    v_cvt_pk_bf16_f32 v92, v52, v53
    v_cvt_pk_bf16_f32 v93, v54, v55
    v_mul_f32 v60, v60, v251
    v_mul_f32 v61, v61, v251
    v_mul_f32 v62, v62, v251
    v_mul_f32 v63, v63, v251
    v_cvt_pk_bf16_f32 v94, v60, v61
    v_cvt_pk_bf16_f32 v95, v62, v63
    buffer_store_dwordx4 v[64:67], v247, s[28:31], s69 offen offset:0 sc1
    buffer_store_dwordx4 v[68:71], v247, s[28:31], s69 offen offset:1024 sc1
    s_add_u32 s69, s69, 4096
    buffer_store_dwordx4 v[72:75], v247, s[28:31], s69 offen offset:0 sc1
    buffer_store_dwordx4 v[76:79], v247, s[28:31], s69 offen offset:1024 sc1
    s_add_u32 s69, s69, 4096
    buffer_store_dwordx4 v[80:83], v247, s[28:31], s69 offen offset:0 sc1
    buffer_store_dwordx4 v[84:87], v247, s[28:31], s69 offen offset:1024 sc1
    s_add_u32 s69, s69, 4096
    buffer_store_dwordx4 v[88:91], v247, s[28:31], s69 offen offset:0 sc1
    buffer_store_dwordx4 v[92:95], v247, s[28:31], s69 offen offset:1024 sc1
    s_and_b32 s83, s2, 3
    s_lshl_b32 s83, s83, 3
    s_lshr_b32 s84, s2, 5
    s_add_u32 s83, s83, s84
    s_bfe_u32 s84, s2, 0x10002
    s_lshl_b32 s84, s84, 2
    s_bfe_u32 s66, s2, 0x20003
    s_add_u32 s84, s84, s66
    v_lshlrev_b32 v224, 4, v249
    v_add_u32 v225, 4096, v224
    s_lshl_b32 s81, s83, 3
    s_add_u32 s81, s81, s33
    s_lshl_b32 s81, s81, 16
    s_lshl_b32 s82, s84, 3
    s_add_u32 s82, s82, s33
    s_mul_i32 s82, s82, 81920
    s_add_u32 s82, s82, 16777216
    s_lshr_b32 s66, s83, 1
    s_lshl_b32 s66, s66, 2
    s_add_u32 s66, s66, s3
    s_lshl_b32 s66, s66, 7
    s_add_u32 s66, s66, s4
    s_lshl_b32 s66, s66, 2
    s_add_u32 s66, s66, 22020096
    v_and_b32 v226, 3, v249
    v_lshlrev_b32 v226, 7, v226
    v_add_u32 v226, s66, v226
    s_barrier
    s_add_u32 s54, s54, 32768
    s_add_u32 s66, s68, 163840
    s_cmp_eq_u32 s54, s66
    s_cselect_b32 s54, s68, s54
    s_add_u32 s55, s54, 16384
    s_add_u32 s52, s52, 16384
    s_mov_b32 m0, s54
    s_waitcnt vmcnt(13)
    buffer_load_dwordx4 v216, s[8:11], s52 offen offset:0 nt lds
    s_waitcnt vmcnt(13)
    buffer_load_dwordx4 v217, s[8:11], s52 offen offset:1024 nt lds
    s_waitcnt vmcnt(13)
    buffer_load_dwordx4 v218, s[8:11], s52 offen offset:2048 nt lds
    s_waitcnt vmcnt(13)
    buffer_load_dwordx4 v219, s[8:11], s52 offen offset:3072 nt lds
    s_mov_b32 m0, s55
    s_waitcnt vmcnt(13)
    buffer_load_dwordx4 v220, s[12:15], s52 offen offset:0 nt lds
    s_waitcnt vmcnt(4)
    buffer_load_dwordx4 v221, s[12:15], s52 offen offset:1024 nt lds
    s_waitcnt vmcnt(4)
    buffer_load_dwordx4 v220, s[12:15], s52 offen offset:2048 nt lds
    s_waitcnt vmcnt(4)
    buffer_load_dwordx4 v221, s[12:15], s52 offen offset:3072 nt lds
    s_waitcnt vmcnt(8)
    v_cmp_gt_u32 vcc, 4, v252
    s_nop 1
    s_cbranch_vccz L_i_x
    s_mov_b32 s67, 0x40000
L_i:
    global_load_dword v253, v248, s[48:49] sc1
    s_waitcnt vmcnt(0)
    v_cmp_gt_u32 vcc, 4, v253
    s_sub_u32 s67, s67, 1
    s_cbranch_scc1 L_i_x
    s_cbranch_vccnz L_i
L_i_x:
    s_barrier
    s_add_u32 s54, s54, 32768
    s_add_u32 s66, s68, 163840
    s_cmp_eq_u32 s54, s66
    s_cselect_b32 s54, s68, s54
    s_add_u32 s55, s54, 16384
    s_add_u32 s52, s52, 16384
    s_mov_b32 m0, s54
    s_waitcnt vmcnt(4)
    buffer_load_dwordx4 v216, s[8:11], s52 offen offset:0 nt lds
    s_cmp_lg_u32 s33, 0
    s_cbranch_scc1 L_f1
    s_mov_b64 exec, 1
    v_mov_b32 v253, 1
    buffer_store_dword v253, off, s[28:31], s80 offset:0 sc1
    s_mov_b64 exec, -1
L_f1:
    s_mov_b32 m0, s54
    s_waitcnt vmcnt(4)
    buffer_load_dwordx4 v217, s[8:11], s52 offen offset:1024 nt lds
    s_waitcnt vmcnt(4)
    buffer_load_dwordx4 v218, s[8:11], s52 offen offset:2048 nt lds
    s_getpc_b64 s[88:89]
L_pc1:
    s_add_u32 s88, s88, L_tail-L_pc1
    s_addc_u32 s89, s89, 0
    s_lshr_b32 s70, s2, 3
    s_lshl_b32 s70, s70, 10
    s_min_u32 s70, s70, L_stop-L_tail-1024
    v_lshlrev_b32 v0, 4, v249
    v_add_u32 v0, s70, v0
    global_load_dwordx4 v[0:3], v0, s[88:89]
    s_mov_b32 m0, s54
    s_waitcnt vmcnt(5)
    buffer_load_dwordx4 v219, s[8:11], s52 offen offset:3072 nt lds
    s_mov_b32 m0, s55
    s_waitcnt vmcnt(5)
    buffer_load_dwordx4 v220, s[12:15], s52 offen offset:0 nt lds
    s_waitcnt vmcnt(5)
    buffer_load_dwordx4 v221, s[12:15], s52 offen offset:1024 nt lds
    s_waitcnt vmcnt(5)
    buffer_load_dwordx4 v220, s[12:15], s52 offen offset:2048 nt lds
    s_waitcnt vmcnt(5)
    buffer_load_dwordx4 v221, s[12:15], s52 offen offset:3072 nt lds
    s_waitcnt vmcnt(9)
    s_mov_b32 s60, 4
L_g0l:
    s_barrier
    s_add_u32 s54, s54, 32768
    s_add_u32 s66, s68, 163840
    s_cmp_eq_u32 s54, s66
    s_cselect_b32 s54, s68, s54
    s_add_u32 s55, s54, 16384
    s_add_u32 s52, s52, 16384
    s_mov_b32 m0, s54
    s_waitcnt vmcnt(4)
    buffer_load_dwordx4 v216, s[8:11], s52 offen offset:0 nt lds
    s_waitcnt vmcnt(4)
    buffer_load_dwordx4 v217, s[8:11], s52 offen offset:1024 nt lds
    s_waitcnt vmcnt(4)
    buffer_load_dwordx4 v218, s[8:11], s52 offen offset:2048 nt lds
    s_waitcnt vmcnt(4)
    buffer_load_dwordx4 v219, s[8:11], s52 offen offset:3072 nt lds
    s_mov_b32 m0, s55
    s_waitcnt vmcnt(4)
    buffer_load_dwordx4 v220, s[12:15], s52 offen offset:0 nt lds
    s_waitcnt vmcnt(4)
    buffer_load_dwordx4 v221, s[12:15], s52 offen offset:1024 nt lds
    s_waitcnt vmcnt(4)
    buffer_load_dwordx4 v220, s[12:15], s52 offen offset:2048 nt lds
    s_waitcnt vmcnt(4)
    buffer_load_dwordx4 v221, s[12:15], s52 offen offset:3072 nt lds
    s_waitcnt vmcnt(8)
    s_sub_u32 s60, s60, 1
    s_cmp_lg_u32 s60, 0
    s_cbranch_scc1 L_g0l
L_tail:
    s_barrier
    s_add_u32 s54, s54, 32768
    s_add_u32 s66, s68, 163840
    s_cmp_eq_u32 s54, s66
    s_cselect_b32 s54, s68, s54
    s_add_u32 s55, s54, 16384
    s_add_u32 s52, s52, 16384
    s_mov_b32 m0, s54
    s_waitcnt vmcnt(4)
    buffer_load_dwordx4 v216, s[8:11], s52 offen offset:0 nt lds
    buffer_load_dwordx4 v[80:83], v224, s[28:31], s82 offen offset:0 sc1
    s_waitcnt vmcnt(5)
    buffer_load_dwordx4 v217, s[8:11], s52 offen offset:1024 nt lds
    s_waitcnt vmcnt(5)
    buffer_load_dwordx4 v218, s[8:11], s52 offen offset:2048 nt lds
    buffer_load_dwordx4 v[84:87], v224, s[28:31], s82 offen offset:1024 sc1
    s_waitcnt vmcnt(6)
    buffer_load_dwordx4 v219, s[8:11], s52 offen offset:3072 nt lds
    s_mov_b32 m0, s55
    s_waitcnt vmcnt(6)
    buffer_load_dwordx4 v220, s[12:15], s52 offen offset:0 nt lds
    buffer_load_dwordx4 v[88:91], v224, s[28:31], s82 offen offset:2048 sc1
    s_waitcnt vmcnt(7)
    buffer_load_dwordx4 v221, s[12:15], s52 offen offset:1024 nt lds
    s_waitcnt vmcnt(6)
    buffer_load_dwordx4 v220, s[12:15], s52 offen offset:2048 nt lds
    buffer_load_dwordx4 v[92:95], v224, s[28:31], s82 offen offset:3072 sc1
    s_waitcnt vmcnt(7)
    buffer_load_dwordx4 v221, s[12:15], s52 offen offset:3072 nt lds
    s_waitcnt vmcnt(12)
    s_barrier
    s_add_u32 s54, s54, 32768
    s_add_u32 s66, s68, 163840
    s_cmp_eq_u32 s54, s66
    s_cselect_b32 s54, s68, s54
    s_add_u32 s55, s54, 16384
    s_add_u32 s52, s52, 16384
    s_mov_b32 m0, s54
    s_waitcnt vmcnt(6)
    buffer_load_dwordx4 v216, s[8:11], s52 offen offset:0 nt lds
    buffer_load_dwordx4 v[96:99], v225, s[28:31], s82 offen offset:0 sc1
    s_waitcnt vmcnt(7)
    buffer_load_dwordx4 v217, s[8:11], s52 offen offset:1024 nt lds
    s_waitcnt vmcnt(6)
    buffer_load_dwordx4 v218, s[8:11], s52 offen offset:2048 nt lds
    s_add_u32 s82, s82, 5120
    buffer_load_dwordx4 v[116:119], v224, s[28:31], s82 offen offset:0 sc1
    s_waitcnt vmcnt(7)
    buffer_load_dwordx4 v219, s[8:11], s52 offen offset:3072 nt lds
    s_mov_b32 m0, s55
    s_waitcnt vmcnt(6)
    buffer_load_dwordx4 v220, s[12:15], s52 offen offset:0 nt lds
    buffer_load_dwordx4 v[120:123], v224, s[28:31], s82 offen offset:1024 sc1
    s_waitcnt vmcnt(7)
    buffer_load_dwordx4 v221, s[12:15], s52 offen offset:1024 nt lds
    s_waitcnt vmcnt(6)
    buffer_load_dwordx4 v220, s[12:15], s52 offen offset:2048 nt lds
    buffer_load_dwordx4 v[124:127], v224, s[28:31], s82 offen offset:2048 sc1
    s_waitcnt vmcnt(7)
    buffer_load_dwordx4 v221, s[12:15], s52 offen offset:3072 nt lds
    s_waitcnt vmcnt(12)
    s_barrier
    s_add_u32 s54, s54, 32768
    s_add_u32 s66, s68, 163840
    s_cmp_eq_u32 s54, s66
    s_cselect_b32 s54, s68, s54
    s_add_u32 s55, s54, 16384
    s_add_u32 s52, s52, 16384
    s_mov_b32 m0, s54
    s_waitcnt vmcnt(11)
    buffer_load_dwordx4 v216, s[8:11], s52 offen offset:0 nt lds
    buffer_load_dwordx4 v[128:131], v224, s[28:31], s82 offen offset:3072 sc1
    s_waitcnt vmcnt(11)
    buffer_load_dwordx4 v217, s[8:11], s52 offen offset:1024 nt lds
    s_waitcnt vmcnt(11)
    buffer_load_dwordx4 v218, s[8:11], s52 offen offset:2048 nt lds
    buffer_load_dwordx4 v[132:135], v225, s[28:31], s82 offen offset:0 sc1
    s_waitcnt vmcnt(11)
    buffer_load_dwordx4 v219, s[8:11], s52 offen offset:3072 nt lds
    s_mov_b32 m0, s55
    s_waitcnt vmcnt(11)
    buffer_load_dwordx4 v220, s[12:15], s52 offen offset:0 nt lds
    s_add_u32 s82, s82, 5120
    buffer_load_dwordx4 v[152:155], v224, s[28:31], s82 offen offset:0 sc1
    s_waitcnt vmcnt(11)
    buffer_load_dwordx4 v221, s[12:15], s52 offen offset:1024 nt lds
    s_waitcnt vmcnt(11)
    buffer_load_dwordx4 v220, s[12:15], s52 offen offset:2048 nt lds
    buffer_load_dwordx4 v[156:159], v224, s[28:31], s82 offen offset:1024 sc1
    s_waitcnt vmcnt(11)
    buffer_load_dwordx4 v221, s[12:15], s52 offen offset:3072 nt lds
    s_waitcnt vmcnt(12)
    s_barrier
    s_add_u32 s54, s54, 32768
    s_add_u32 s66, s68, 163840
    s_cmp_eq_u32 s54, s66
    s_cselect_b32 s54, s68, s54
    s_add_u32 s55, s54, 16384
    s_add_u32 s52, s52, 16384
    s_mov_b32 m0, s54
    s_waitcnt vmcnt(11)
    buffer_load_dwordx4 v216, s[8:11], s52 offen offset:0 nt lds
    buffer_load_dwordx4 v[160:163], v224, s[28:31], s82 offen offset:2048 sc1
    s_waitcnt vmcnt(11)
    buffer_load_dwordx4 v217, s[8:11], s52 offen offset:1024 nt lds
    buffer_load_dword v247, v226, s[28:31], 0 offen sc1
    s_waitcnt vmcnt(12)
    buffer_load_dwordx4 v218, s[8:11], s52 offen offset:2048 nt lds
    buffer_load_dwordx4 v[164:167], v224, s[28:31], s82 offen offset:3072 sc1
    s_waitcnt vmcnt(12)
    buffer_load_dwordx4 v219, s[8:11], s52 offen offset:3072 nt lds
    s_mov_b32 m0, s55
    s_waitcnt vmcnt(12)
    buffer_load_dwordx4 v220, s[12:15], s52 offen offset:0 nt lds
    buffer_load_dwordx4 v[168:171], v225, s[28:31], s82 offen offset:0 sc1
    s_waitcnt vmcnt(12)
    buffer_load_dwordx4 v221, s[12:15], s52 offen offset:1024 nt lds
    s_waitcnt vmcnt(12)
    buffer_load_dwordx4 v220, s[12:15], s52 offen offset:2048 nt lds
    s_add_u32 s82, s82, 5120
    buffer_load_dwordx4 v[188:191], v224, s[28:31], s82 offen offset:0 sc1
    s_waitcnt vmcnt(12)
    buffer_load_dwordx4 v221, s[12:15], s52 offen offset:3072 nt lds
    s_waitcnt vmcnt(13)
    s_barrier
    v_mov_b32 v250, 65536
    v_mov_b32 v252, 0
    v_mov_b32 v253, 0
    ds_write_b64 v250, v[252:253]
    s_add_u32 s54, s54, 32768
    s_add_u32 s66, s68, 163840
    s_cmp_eq_u32 s54, s66
    s_cselect_b32 s54, s68, s54
    s_add_u32 s55, s54, 16384
    s_add_u32 s52, s52, 16384
    s_mov_b32 m0, s54
    s_waitcnt vmcnt(12)
    buffer_load_dwordx4 v216, s[8:11], s52 offen offset:0 nt lds
    buffer_load_dwordx4 v[192:195], v224, s[28:31], s82 offen offset:1024 sc1
    s_waitcnt vmcnt(12)
    buffer_load_dwordx4 v217, s[8:11], s52 offen offset:1024 nt lds
    s_waitcnt vmcnt(11)
    buffer_load_dwordx4 v218, s[8:11], s52 offen offset:2048 nt lds
    buffer_load_dwordx4 v[196:199], v224, s[28:31], s82 offen offset:2048 sc1
    s_waitcnt vmcnt(11)
    buffer_load_dwordx4 v219, s[8:11], s52 offen offset:3072 nt lds
    s_mov_b32 m0, s55
    s_waitcnt vmcnt(11)
    buffer_load_dwordx4 v220, s[12:15], s52 offen offset:0 nt lds
    buffer_load_dwordx4 v[200:203], v224, s[28:31], s82 offen offset:3072 sc1
    s_waitcnt vmcnt(11)
    buffer_load_dwordx4 v221, s[12:15], s52 offen offset:1024 nt lds
    s_waitcnt vmcnt(11)
    buffer_load_dwordx4 v220, s[12:15], s52 offen offset:2048 nt lds
    buffer_load_dwordx4 v[204:207], v225, s[28:31], s82 offen offset:0 sc1
    s_waitcnt vmcnt(11)
    buffer_load_dwordx4 v221, s[12:15], s52 offen offset:3072 nt lds
    s_waitcnt vmcnt(12)
    s_waitcnt lgkmcnt(0)
    s_setprio 0
    s_barrier
    v_cmp_gt_u32 vcc, 1, v247
    s_nop 1
    s_cbranch_vccz L_r_x
    s_mov_b32 s67, 0x40000
L_r:
    buffer_load_dword v253, v226, s[28:31], 0 offen sc1
    s_waitcnt vmcnt(0)
    v_cmp_gt_u32 vcc, 1, v253
    s_sub_u32 s67, s67, 1
    s_cbranch_scc1 L_r_x
    s_cbranch_vccnz L_r
L_r_x:
    s_add_u32 s82, s82, 5120
    buffer_load_dwordx4 v[100:103], v224, s[28:31], s81 offen offset:0 sc1
    buffer_load_dwordx4 v[104:107], v224, s[28:31], s81 offen offset:1024 sc1
    buffer_load_dwordx4 v[108:111], v224, s[28:31], s81 offen offset:2048 sc1
    buffer_load_dwordx4 v[112:115], v224, s[28:31], s81 offen offset:3072 sc1
    s_add_u32 s81, s81, 4096
    buffer_load_dwordx4 v[136:139], v224, s[28:31], s81 offen offset:0 sc1
    buffer_load_dwordx4 v[140:143], v224, s[28:31], s81 offen offset:1024 sc1
    buffer_load_dwordx4 v[144:147], v224, s[28:31], s81 offen offset:2048 sc1
    buffer_load_dwordx4 v[148:151], v224, s[28:31], s81 offen offset:3072 sc1
    s_add_u32 s81, s81, 4096
    buffer_load_dwordx4 v[172:175], v224, s[28:31], s81 offen offset:0 sc1
    buffer_load_dwordx4 v[176:179], v224, s[28:31], s81 offen offset:1024 sc1
    buffer_load_dwordx4 v[180:183], v224, s[28:31], s81 offen offset:2048 sc1
    buffer_load_dwordx4 v[184:187], v224, s[28:31], s81 offen offset:3072 sc1
    s_add_u32 s81, s81, 4096
    buffer_load_dwordx4 v[208:211], v224, s[28:31], s81 offen offset:0 sc1
    buffer_load_dwordx4 v[212:215], v224, s[28:31], s81 offen offset:1024 sc1
    buffer_load_dwordx4 v[216:219], v224, s[28:31], s81 offen offset:2048 sc1
    buffer_load_dwordx4 v[220:223], v224, s[28:31], s81 offen offset:3072 sc1
    s_add_u32 s81, s81, 4096
    s_barrier
    s_branch L_gemm
L_g1e:
    s_nop 0
    v_permlane32_swap_b32 v245, v246
    v_add_f32 v245, v245, v246
    v_mov_b32 v246, v245
    v_lshlrev_b32 v247, 4, v249
    s_nop 0
    v_permlane16_swap_b32 v245, v246
    v_add_f32 v245, v245, v246
    v_rcp_f32 v245, v245
    s_nop 0
    v_mov_b32 v250, v245
    v_mov_b32 v251, v245
    s_nop 1
    v_permlane32_swap_b32 v250, v251
    v_mul_f32 v0, v0, v250
    v_mul_f32 v1, v1, v250
    v_mul_f32 v2, v2, v250
    v_mul_f32 v3, v3, v250
    v_cvt_pk_bf16_f32 v64, v0, v1
    v_cvt_pk_bf16_f32 v65, v2, v3
    v_mul_f32 v8, v8, v250
    v_mul_f32 v9, v9, v250
    v_mul_f32 v10, v10, v250
    v_mul_f32 v11, v11, v250
    v_cvt_pk_bf16_f32 v66, v8, v9
    v_cvt_pk_bf16_f32 v67, v10, v11
    buffer_store_dwordx4 v[64:67], v247, s[28:31], s69 offen offset:0 sc1
    v_mul_f32 v4, v4, v251
    v_mul_f32 v5, v5, v251
    v_mul_f32 v6, v6, v251
    v_mul_f32 v7, v7, v251
    v_cvt_pk_bf16_f32 v68, v4, v5
    v_cvt_pk_bf16_f32 v69, v6, v7
    v_mul_f32 v12, v12, v251
    v_mul_f32 v13, v13, v251
    v_mul_f32 v14, v14, v251
    v_mul_f32 v15, v15, v251
    v_cvt_pk_bf16_f32 v70, v12, v13
    v_cvt_pk_bf16_f32 v71, v14, v15
    buffer_store_dwordx4 v[68:71], v247, s[28:31], s69 offen offset:1024 sc1
    v_mul_f32 v16, v16, v250
    v_mul_f32 v17, v17, v250
    v_mul_f32 v18, v18, v250
    v_mul_f32 v19, v19, v250
    v_cvt_pk_bf16_f32 v72, v16, v17
    v_cvt_pk_bf16_f32 v73, v18, v19
    v_mul_f32 v24, v24, v250
    v_mul_f32 v25, v25, v250
    v_mul_f32 v26, v26, v250
    v_mul_f32 v27, v27, v250
    v_cvt_pk_bf16_f32 v74, v24, v25
    v_cvt_pk_bf16_f32 v75, v26, v27
    s_add_u32 s69, s69, 4096
    buffer_store_dwordx4 v[72:75], v247, s[28:31], s69 offen offset:0 sc1
    v_mul_f32 v20, v20, v251
    v_mul_f32 v21, v21, v251
    v_mul_f32 v22, v22, v251
    v_mul_f32 v23, v23, v251
    v_cvt_pk_bf16_f32 v76, v20, v21
    v_cvt_pk_bf16_f32 v77, v22, v23
    v_mul_f32 v28, v28, v251
    v_mul_f32 v29, v29, v251
    v_mul_f32 v30, v30, v251
    v_mul_f32 v31, v31, v251
    v_cvt_pk_bf16_f32 v78, v28, v29
    v_cvt_pk_bf16_f32 v79, v30, v31
    buffer_store_dwordx4 v[76:79], v247, s[28:31], s69 offen offset:1024 sc1
    v_mul_f32 v32, v32, v250
    v_mul_f32 v33, v33, v250
    v_mul_f32 v34, v34, v250
    v_mul_f32 v35, v35, v250
    v_cvt_pk_bf16_f32 v80, v32, v33
    v_cvt_pk_bf16_f32 v81, v34, v35
    v_mul_f32 v40, v40, v250
    v_mul_f32 v41, v41, v250
    v_mul_f32 v42, v42, v250
    v_mul_f32 v43, v43, v250
    v_cvt_pk_bf16_f32 v82, v40, v41
    v_cvt_pk_bf16_f32 v83, v42, v43
    s_add_u32 s69, s69, 4096
    buffer_store_dwordx4 v[80:83], v247, s[28:31], s69 offen offset:0 sc1
    v_mul_f32 v36, v36, v251
    v_mul_f32 v37, v37, v251
    v_mul_f32 v38, v38, v251
    v_mul_f32 v39, v39, v251
    v_cvt_pk_bf16_f32 v84, v36, v37
    v_cvt_pk_bf16_f32 v85, v38, v39
    v_mul_f32 v44, v44, v251
    v_mul_f32 v45, v45, v251
    v_mul_f32 v46, v46, v251
    v_mul_f32 v47, v47, v251
    v_cvt_pk_bf16_f32 v86, v44, v45
    v_cvt_pk_bf16_f32 v87, v46, v47
    buffer_store_dwordx4 v[84:87], v247, s[28:31], s69 offen offset:1024 sc1
    v_mul_f32 v48, v48, v250
    v_mul_f32 v49, v49, v250
    v_mul_f32 v50, v50, v250
    v_mul_f32 v51, v51, v250
    v_cvt_pk_bf16_f32 v88, v48, v49
    v_cvt_pk_bf16_f32 v89, v50, v51
    v_mul_f32 v56, v56, v250
    v_mul_f32 v57, v57, v250
    v_mul_f32 v58, v58, v250
    v_mul_f32 v59, v59, v250
    v_cvt_pk_bf16_f32 v90, v56, v57
    v_cvt_pk_bf16_f32 v91, v58, v59
    s_add_u32 s69, s69, 4096
    buffer_store_dwordx4 v[88:91], v247, s[28:31], s69 offen offset:0 sc1
    v_mul_f32 v52, v52, v251
    v_mul_f32 v53, v53, v251
    v_mul_f32 v54, v54, v251
    v_mul_f32 v55, v55, v251
    v_cvt_pk_bf16_f32 v92, v52, v53
    v_cvt_pk_bf16_f32 v93, v54, v55
    v_mul_f32 v60, v60, v251
    v_mul_f32 v61, v61, v251
    v_mul_f32 v62, v62, v251
    v_mul_f32 v63, v63, v251
    v_cvt_pk_bf16_f32 v94, v60, v61
    v_cvt_pk_bf16_f32 v95, v62, v63
    buffer_store_dwordx4 v[92:95], v247, s[28:31], s69 offen offset:1024 sc1
    s_and_b32 s83, s2, 3
    s_lshl_b32 s83, s83, 3
    s_lshr_b32 s84, s2, 5
    s_add_u32 s83, s83, s84
    s_bfe_u32 s84, s2, 0x10002
    s_lshl_b32 s84, s84, 2
    s_bfe_u32 s66, s2, 0x20003
    s_add_u32 s84, s84, s66
    v_lshlrev_b32 v224, 4, v249
    v_add_u32 v225, 4096, v224
    s_lshl_b32 s81, s83, 3
    s_add_u32 s81, s81, s33
    s_lshl_b32 s81, s81, 16
    s_lshl_b32 s82, s84, 3
    s_add_u32 s82, s82, s33
    s_mul_i32 s82, s82, 81920
    s_add_u32 s82, s82, 16777216
    s_lshr_b32 s66, s83, 1
    s_lshl_b32 s66, s66, 2
    s_add_u32 s66, s66, s3
    s_lshl_b32 s66, s66, 7
    s_add_u32 s66, s66, s4
    s_lshl_b32 s66, s66, 2
    s_add_u32 s66, s66, 22020096
    v_and_b32 v226, 3, v249
    v_lshlrev_b32 v226, 7, v226
    v_add_u32 v226, s66, v226
    s_waitcnt vmcnt(0)
    v_mov_b32 v250, 65540
    v_mov_b32 v251, 1
    s_mov_b64 exec, 1
    ds_add_rtn_u32 v252, v250, v251
    s_waitcnt lgkmcnt(0)
    v_cmp_eq_u32 vcc, 3, v252
    s_nop 1
    s_cbranch_vccz L_f2
    v_mov_b32 v253, 1
    buffer_store_dword v253, off, s[28:31], s80 offset:4 sc1
L_f2:
    s_mov_b64 exec, -1
    buffer_load_dwordx4 v[80:83], v224, s[28:31], s82 offen offset:0 sc1
    buffer_load_dwordx4 v[84:87], v224, s[28:31], s82 offen offset:1024 sc1
    buffer_load_dwordx4 v[88:91], v224, s[28:31], s82 offen offset:2048 sc1
    buffer_load_dwordx4 v[92:95], v224, s[28:31], s82 offen offset:3072 sc1
    buffer_load_dwordx4 v[96:99], v225, s[28:31], s82 offen offset:0 sc1
    s_add_u32 s82, s82, 5120
    buffer_load_dwordx4 v[116:119], v224, s[28:31], s82 offen offset:0 sc1
    buffer_load_dwordx4 v[120:123], v224, s[28:31], s82 offen offset:1024 sc1
    buffer_load_dwordx4 v[124:127], v224, s[28:31], s82 offen offset:2048 sc1
    buffer_load_dwordx4 v[128:131], v224, s[28:31], s82 offen offset:3072 sc1
    buffer_load_dwordx4 v[132:135], v225, s[28:31], s82 offen offset:0 sc1
    s_add_u32 s82, s82, 5120
    buffer_load_dwordx4 v[152:155], v224, s[28:31], s82 offen offset:0 sc1
    buffer_load_dwordx4 v[156:159], v224, s[28:31], s82 offen offset:1024 sc1
    buffer_load_dwordx4 v[160:163], v224, s[28:31], s82 offen offset:2048 sc1
    buffer_load_dwordx4 v[164:167], v224, s[28:31], s82 offen offset:3072 sc1
    buffer_load_dwordx4 v[168:171], v225, s[28:31], s82 offen offset:0 sc1
    s_add_u32 s82, s82, 5120
    buffer_load_dwordx4 v[188:191], v224, s[28:31], s82 offen offset:0 sc1
    buffer_load_dwordx4 v[192:195], v224, s[28:31], s82 offen offset:1024 sc1
    buffer_load_dwordx4 v[196:199], v224, s[28:31], s82 offen offset:2048 sc1
    buffer_load_dwordx4 v[200:203], v224, s[28:31], s82 offen offset:3072 sc1
    buffer_load_dwordx4 v[204:207], v225, s[28:31], s82 offen offset:0 sc1
    s_add_u32 s82, s82, 5120
    s_setprio 0
    s_mov_b32 s67, 0x40000
L_p:
    buffer_load_dword v253, v226, s[28:31], 0 offen sc1
    s_waitcnt vmcnt(0)
    v_cmp_gt_u32 vcc, 1, v253
    s_sub_u32 s67, s67, 1
    s_cbranch_scc1 L_p_x
    s_cbranch_vccnz L_p
L_p_x:
    buffer_load_dwordx4 v[100:103], v224, s[28:31], s81 offen offset:0 sc1
    buffer_load_dwordx4 v[104:107], v224, s[28:31], s81 offen offset:1024 sc1
    buffer_load_dwordx4 v[108:111], v224, s[28:31], s81 offen offset:2048 sc1
    buffer_load_dwordx4 v[112:115], v224, s[28:31], s81 offen offset:3072 sc1
    s_add_u32 s81, s81, 4096
    buffer_load_dwordx4 v[136:139], v224, s[28:31], s81 offen offset:0 sc1
    buffer_load_dwordx4 v[140:143], v224, s[28:31], s81 offen offset:1024 sc1
    buffer_load_dwordx4 v[144:147], v224, s[28:31], s81 offen offset:2048 sc1
    buffer_load_dwordx4 v[148:151], v224, s[28:31], s81 offen offset:3072 sc1
    s_add_u32 s81, s81, 4096
    buffer_load_dwordx4 v[172:175], v224, s[28:31], s81 offen offset:0 sc1
    buffer_load_dwordx4 v[176:179], v224, s[28:31], s81 offen offset:1024 sc1
    buffer_load_dwordx4 v[180:183], v224, s[28:31], s81 offen offset:2048 sc1
    buffer_load_dwordx4 v[184:187], v224, s[28:31], s81 offen offset:3072 sc1
    s_add_u32 s81, s81, 4096
    buffer_load_dwordx4 v[208:211], v224, s[28:31], s81 offen offset:0 sc1
    buffer_load_dwordx4 v[212:215], v224, s[28:31], s81 offen offset:1024 sc1
    buffer_load_dwordx4 v[216:219], v224, s[28:31], s81 offen offset:2048 sc1
    buffer_load_dwordx4 v[220:223], v224, s[28:31], s81 offen offset:3072 sc1
    s_add_u32 s81, s81, 4096
    s_cmp_eq_u32 s33, 7
    s_cselect_b32 s66, 7, 4
    v_mov_b32 v250, 65540
    v_mov_b32 v251, 1
    s_mov_b32 s67, 0x40000
L_c:
    ds_read_b32 v252, v250
    s_waitcnt lgkmcnt(0)
    v_cmp_gt_u32 vcc, s66, v252
    s_sub_u32 s67, s67, 1
    s_cbranch_scc1 L_c_x
    s_cbranch_vccnz L_c
L_c_x:
    s_mov_b64 exec, 1
    ds_add_u32 v250, v251
    s_mov_b64 exec, -1
    s_waitcnt lgkmcnt(0)
L_gemm:
    s_waitcnt vmcnt(12)
    v_mfma_f32_16x16x32_bf16 v[0:3], v[80:83], v[100:103], 0
    v_mfma_f32_16x16x32_bf16 v[4:7], v[80:83], v[104:107], 0
    v_mfma_f32_16x16x32_bf16 v[8:11], v[80:83], v[108:111], 0
    v_mfma_f32_16x16x32_bf16 v[12:15], v[80:83], v[112:115], 0
    buffer_load_dwordx4 v[80:83], v224, s[28:31], s82 offen offset:0 sc1
    v_mfma_f32_16x16x32_bf16 v[16:19], v[84:87], v[100:103], 0
    v_mfma_f32_16x16x32_bf16 v[20:23], v[84:87], v[104:107], 0
    v_mfma_f32_16x16x32_bf16 v[24:27], v[84:87], v[108:111], 0
    v_mfma_f32_16x16x32_bf16 v[28:31], v[84:87], v[112:115], 0
    buffer_load_dwordx4 v[84:87], v224, s[28:31], s82 offen offset:1024 sc1
    v_mfma_f32_16x16x32_bf16 v[32:35], v[88:91], v[100:103], 0
    v_mfma_f32_16x16x32_bf16 v[36:39], v[88:91], v[104:107], 0
    v_mfma_f32_16x16x32_bf16 v[40:43], v[88:91], v[108:111], 0
    v_mfma_f32_16x16x32_bf16 v[44:47], v[88:91], v[112:115], 0
    buffer_load_dwordx4 v[88:91], v224, s[28:31], s82 offen offset:2048 sc1
    v_mfma_f32_16x16x32_bf16 v[48:51], v[92:95], v[100:103], 0
    v_mfma_f32_16x16x32_bf16 v[52:55], v[92:95], v[104:107], 0
    v_mfma_f32_16x16x32_bf16 v[56:59], v[92:95], v[108:111], 0
    v_mfma_f32_16x16x32_bf16 v[60:63], v[92:95], v[112:115], 0
    buffer_load_dwordx4 v[92:95], v224, s[28:31], s82 offen offset:3072 sc1
    v_mfma_f32_16x16x32_bf16 v[64:67], v[96:99], v[100:103], 0
    buffer_load_dwordx4 v[100:103], v224, s[28:31], s81 offen offset:0 sc1
    v_mfma_f32_16x16x32_bf16 v[68:71], v[96:99], v[104:107], 0
    buffer_load_dwordx4 v[104:107], v224, s[28:31], s81 offen offset:1024 sc1
    v_mfma_f32_16x16x32_bf16 v[72:75], v[96:99], v[108:111], 0
    buffer_load_dwordx4 v[108:111], v224, s[28:31], s81 offen offset:2048 sc1
    v_mfma_f32_16x16x32_bf16 v[76:79], v[96:99], v[112:115], 0
    buffer_load_dwordx4 v[112:115], v224, s[28:31], s81 offen offset:3072 sc1
    buffer_load_dwordx4 v[96:99], v225, s[28:31], s82 offen offset:0 sc1
    s_add_u32 s82, s82, 5120
    s_add_u32 s81, s81, 4096
    s_waitcnt vmcnt(17)
    v_mfma_f32_16x16x32_bf16 v[0:3], v[116:119], v[136:139], v[0:3]
    v_mfma_f32_16x16x32_bf16 v[4:7], v[116:119], v[140:143], v[4:7]
    v_mfma_f32_16x16x32_bf16 v[8:11], v[116:119], v[144:147], v[8:11]
    v_mfma_f32_16x16x32_bf16 v[12:15], v[116:119], v[148:151], v[12:15]
    buffer_load_dwordx4 v[116:119], v224, s[28:31], s82 offen offset:0 sc1
    v_mfma_f32_16x16x32_bf16 v[16:19], v[120:123], v[136:139], v[16:19]
    v_mfma_f32_16x16x32_bf16 v[20:23], v[120:123], v[140:143], v[20:23]
    v_mfma_f32_16x16x32_bf16 v[24:27], v[120:123], v[144:147], v[24:27]
    v_mfma_f32_16x16x32_bf16 v[28:31], v[120:123], v[148:151], v[28:31]
    buffer_load_dwordx4 v[120:123], v224, s[28:31], s82 offen offset:1024 sc1
    v_mfma_f32_16x16x32_bf16 v[32:35], v[124:127], v[136:139], v[32:35]
    v_mfma_f32_16x16x32_bf16 v[36:39], v[124:127], v[140:143], v[36:39]
    v_mfma_f32_16x16x32_bf16 v[40:43], v[124:127], v[144:147], v[40:43]
    v_mfma_f32_16x16x32_bf16 v[44:47], v[124:127], v[148:151], v[44:47]
    buffer_load_dwordx4 v[124:127], v224, s[28:31], s82 offen offset:2048 sc1
    v_mfma_f32_16x16x32_bf16 v[48:51], v[128:131], v[136:139], v[48:51]
    v_mfma_f32_16x16x32_bf16 v[52:55], v[128:131], v[140:143], v[52:55]
    v_mfma_f32_16x16x32_bf16 v[56:59], v[128:131], v[144:147], v[56:59]
    v_mfma_f32_16x16x32_bf16 v[60:63], v[128:131], v[148:151], v[60:63]
    buffer_load_dwordx4 v[128:131], v224, s[28:31], s82 offen offset:3072 sc1
    v_mfma_f32_16x16x32_bf16 v[64:67], v[132:135], v[136:139], v[64:67]
    buffer_load_dwordx4 v[136:139], v224, s[28:31], s81 offen offset:0 sc1
    v_mfma_f32_16x16x32_bf16 v[68:71], v[132:135], v[140:143], v[68:71]
    buffer_load_dwordx4 v[140:143], v224, s[28:31], s81 offen offset:1024 sc1
    v_mfma_f32_16x16x32_bf16 v[72:75], v[132:135], v[144:147], v[72:75]
    buffer_load_dwordx4 v[144:147], v224, s[28:31], s81 offen offset:2048 sc1
    v_mfma_f32_16x16x32_bf16 v[76:79], v[132:135], v[148:151], v[76:79]
    buffer_load_dwordx4 v[148:151], v224, s[28:31], s81 offen offset:3072 sc1
    buffer_load_dwordx4 v[132:135], v225, s[28:31], s82 offen offset:0 sc1
    s_add_u32 s82, s82, 5120
    s_add_u32 s81, s81, 4096
    s_cmp_lg_u32 s4, 0
    s_cbranch_scc1 L_n31
    s_waitcnt vmcnt(18)
    s_barrier
L_n31:
    s_waitcnt vmcnt(22)
    v_mfma_f32_16x16x32_bf16 v[0:3], v[152:155], v[172:175], v[0:3]
    v_mfma_f32_16x16x32_bf16 v[4:7], v[152:155], v[176:179], v[4:7]
    v_mfma_f32_16x16x32_bf16 v[8:11], v[152:155], v[180:183], v[8:11]
    v_mfma_f32_16x16x32_bf16 v[12:15], v[152:155], v[184:187], v[12:15]
    buffer_load_dwordx4 v[152:155], v224, s[28:31], s82 offen offset:0 sc1
    v_mfma_f32_16x16x32_bf16 v[16:19], v[156:159], v[172:175], v[16:19]
    v_mfma_f32_16x16x32_bf16 v[20:23], v[156:159], v[176:179], v[20:23]
    v_mfma_f32_16x16x32_bf16 v[24:27], v[156:159], v[180:183], v[24:27]
    v_mfma_f32_16x16x32_bf16 v[28:31], v[156:159], v[184:187], v[28:31]
    buffer_load_dwordx4 v[156:159], v224, s[28:31], s82 offen offset:1024 sc1
    v_mfma_f32_16x16x32_bf16 v[32:35], v[160:163], v[172:175], v[32:35]
    v_mfma_f32_16x16x32_bf16 v[36:39], v[160:163], v[176:179], v[36:39]
    v_mfma_f32_16x16x32_bf16 v[40:43], v[160:163], v[180:183], v[40:43]
    v_mfma_f32_16x16x32_bf16 v[44:47], v[160:163], v[184:187], v[44:47]
    buffer_load_dwordx4 v[160:163], v224, s[28:31], s82 offen offset:2048 sc1
    v_mfma_f32_16x16x32_bf16 v[48:51], v[164:167], v[172:175], v[48:51]
    v_mfma_f32_16x16x32_bf16 v[52:55], v[164:167], v[176:179], v[52:55]
    v_mfma_f32_16x16x32_bf16 v[56:59], v[164:167], v[180:183], v[56:59]
    v_mfma_f32_16x16x32_bf16 v[60:63], v[164:167], v[184:187], v[60:63]
    buffer_load_dwordx4 v[164:167], v224, s[28:31], s82 offen offset:3072 sc1
    v_mfma_f32_16x16x32_bf16 v[64:67], v[168:171], v[172:175], v[64:67]
    buffer_load_dwordx4 v[172:175], v224, s[28:31], s81 offen offset:0 sc1
    v_mfma_f32_16x16x32_bf16 v[68:71], v[168:171], v[176:179], v[68:71]
    buffer_load_dwordx4 v[176:179], v224, s[28:31], s81 offen offset:1024 sc1
    v_mfma_f32_16x16x32_bf16 v[72:75], v[168:171], v[180:183], v[72:75]
    buffer_load_dwordx4 v[180:183], v224, s[28:31], s81 offen offset:2048 sc1
    v_mfma_f32_16x16x32_bf16 v[76:79], v[168:171], v[184:187], v[76:79]
    buffer_load_dwordx4 v[184:187], v224, s[28:31], s81 offen offset:3072 sc1
    buffer_load_dwordx4 v[168:171], v225, s[28:31], s82 offen offset:0 sc1
    s_add_u32 s82, s82, 5120
    s_add_u32 s81, s81, 4096
    s_waitcnt vmcnt(27)
    v_mfma_f32_16x16x32_bf16 v[0:3], v[188:191], v[208:211], v[0:3]
    v_mfma_f32_16x16x32_bf16 v[4:7], v[188:191], v[212:215], v[4:7]
    v_mfma_f32_16x16x32_bf16 v[8:11], v[188:191], v[216:219], v[8:11]
    v_mfma_f32_16x16x32_bf16 v[12:15], v[188:191], v[220:223], v[12:15]
    buffer_load_dwordx4 v[188:191], v224, s[28:31], s82 offen offset:0 sc1
    v_mfma_f32_16x16x32_bf16 v[16:19], v[192:195], v[208:211], v[16:19]
    v_mfma_f32_16x16x32_bf16 v[20:23], v[192:195], v[212:215], v[20:23]
    v_mfma_f32_16x16x32_bf16 v[24:27], v[192:195], v[216:219], v[24:27]
    v_mfma_f32_16x16x32_bf16 v[28:31], v[192:195], v[220:223], v[28:31]
    buffer_load_dwordx4 v[192:195], v224, s[28:31], s82 offen offset:1024 sc1
    v_mfma_f32_16x16x32_bf16 v[32:35], v[196:199], v[208:211], v[32:35]
    v_mfma_f32_16x16x32_bf16 v[36:39], v[196:199], v[212:215], v[36:39]
    v_mfma_f32_16x16x32_bf16 v[40:43], v[196:199], v[216:219], v[40:43]
    v_mfma_f32_16x16x32_bf16 v[44:47], v[196:199], v[220:223], v[44:47]
    buffer_load_dwordx4 v[196:199], v224, s[28:31], s82 offen offset:2048 sc1
    v_mfma_f32_16x16x32_bf16 v[48:51], v[200:203], v[208:211], v[48:51]
    v_mfma_f32_16x16x32_bf16 v[52:55], v[200:203], v[212:215], v[52:55]
    v_mfma_f32_16x16x32_bf16 v[56:59], v[200:203], v[216:219], v[56:59]
    v_mfma_f32_16x16x32_bf16 v[60:63], v[200:203], v[220:223], v[60:63]
    buffer_load_dwordx4 v[200:203], v224, s[28:31], s82 offen offset:3072 sc1
    v_mfma_f32_16x16x32_bf16 v[64:67], v[204:207], v[208:211], v[64:67]
    buffer_load_dwordx4 v[208:211], v224, s[28:31], s81 offen offset:0 sc1
    v_mfma_f32_16x16x32_bf16 v[68:71], v[204:207], v[212:215], v[68:71]
    buffer_load_dwordx4 v[212:215], v224, s[28:31], s81 offen offset:1024 sc1
    v_mfma_f32_16x16x32_bf16 v[72:75], v[204:207], v[216:219], v[72:75]
    buffer_load_dwordx4 v[216:219], v224, s[28:31], s81 offen offset:2048 sc1
    v_mfma_f32_16x16x32_bf16 v[76:79], v[204:207], v[220:223], v[76:79]
    buffer_load_dwordx4 v[220:223], v224, s[28:31], s81 offen offset:3072 sc1
    buffer_load_dwordx4 v[204:207], v225, s[28:31], s82 offen offset:0 sc1
    s_add_u32 s82, s82, 5120
    s_add_u32 s81, s81, 4096
    s_sub_u32 s60, 2, s4
L_gl:
    s_waitcnt vmcnt(27)
    v_mfma_f32_16x16x32_bf16 v[0:3], v[80:83], v[100:103], v[0:3]
    v_mfma_f32_16x16x32_bf16 v[4:7], v[80:83], v[104:107], v[4:7]
    v_mfma_f32_16x16x32_bf16 v[8:11], v[80:83], v[108:111], v[8:11]
    v_mfma_f32_16x16x32_bf16 v[12:15], v[80:83], v[112:115], v[12:15]
    buffer_load_dwordx4 v[80:83], v224, s[28:31], s82 offen offset:0 sc1
    v_mfma_f32_16x16x32_bf16 v[16:19], v[84:87], v[100:103], v[16:19]
    v_mfma_f32_16x16x32_bf16 v[20:23], v[84:87], v[104:107], v[20:23]
    v_mfma_f32_16x16x32_bf16 v[24:27], v[84:87], v[108:111], v[24:27]
    v_mfma_f32_16x16x32_bf16 v[28:31], v[84:87], v[112:115], v[28:31]
    buffer_load_dwordx4 v[84:87], v224, s[28:31], s82 offen offset:1024 sc1
    v_mfma_f32_16x16x32_bf16 v[32:35], v[88:91], v[100:103], v[32:35]
    v_mfma_f32_16x16x32_bf16 v[36:39], v[88:91], v[104:107], v[36:39]
    v_mfma_f32_16x16x32_bf16 v[40:43], v[88:91], v[108:111], v[40:43]
    v_mfma_f32_16x16x32_bf16 v[44:47], v[88:91], v[112:115], v[44:47]
    buffer_load_dwordx4 v[88:91], v224, s[28:31], s82 offen offset:2048 sc1
    v_mfma_f32_16x16x32_bf16 v[48:51], v[92:95], v[100:103], v[48:51]
    v_mfma_f32_16x16x32_bf16 v[52:55], v[92:95], v[104:107], v[52:55]
    v_mfma_f32_16x16x32_bf16 v[56:59], v[92:95], v[108:111], v[56:59]
    v_mfma_f32_16x16x32_bf16 v[60:63], v[92:95], v[112:115], v[60:63]
    buffer_load_dwordx4 v[92:95], v224, s[28:31], s82 offen offset:3072 sc1
    v_mfma_f32_16x16x32_bf16 v[64:67], v[96:99], v[100:103], v[64:67]
    buffer_load_dwordx4 v[100:103], v224, s[28:31], s81 offen offset:0 sc1
    v_mfma_f32_16x16x32_bf16 v[68:71], v[96:99], v[104:107], v[68:71]
    buffer_load_dwordx4 v[104:107], v224, s[28:31], s81 offen offset:1024 sc1
    v_mfma_f32_16x16x32_bf16 v[72:75], v[96:99], v[108:111], v[72:75]
    buffer_load_dwordx4 v[108:111], v224, s[28:31], s81 offen offset:2048 sc1
    v_mfma_f32_16x16x32_bf16 v[76:79], v[96:99], v[112:115], v[76:79]
    buffer_load_dwordx4 v[112:115], v224, s[28:31], s81 offen offset:3072 sc1
    buffer_load_dwordx4 v[96:99], v225, s[28:31], s82 offen offset:0 sc1
    s_add_u32 s82, s82, 5120
    s_add_u32 s81, s81, 4096
    s_waitcnt vmcnt(27)
    v_mfma_f32_16x16x32_bf16 v[0:3], v[116:119], v[136:139], v[0:3]
    v_mfma_f32_16x16x32_bf16 v[4:7], v[116:119], v[140:143], v[4:7]
    v_mfma_f32_16x16x32_bf16 v[8:11], v[116:119], v[144:147], v[8:11]
    v_mfma_f32_16x16x32_bf16 v[12:15], v[116:119], v[148:151], v[12:15]
    buffer_load_dwordx4 v[116:119], v224, s[28:31], s82 offen offset:0 sc1
    v_mfma_f32_16x16x32_bf16 v[16:19], v[120:123], v[136:139], v[16:19]
    v_mfma_f32_16x16x32_bf16 v[20:23], v[120:123], v[140:143], v[20:23]
    v_mfma_f32_16x16x32_bf16 v[24:27], v[120:123], v[144:147], v[24:27]
    v_mfma_f32_16x16x32_bf16 v[28:31], v[120:123], v[148:151], v[28:31]
    buffer_load_dwordx4 v[120:123], v224, s[28:31], s82 offen offset:1024 sc1
    v_mfma_f32_16x16x32_bf16 v[32:35], v[124:127], v[136:139], v[32:35]
    v_mfma_f32_16x16x32_bf16 v[36:39], v[124:127], v[140:143], v[36:39]
    v_mfma_f32_16x16x32_bf16 v[40:43], v[124:127], v[144:147], v[40:43]
    v_mfma_f32_16x16x32_bf16 v[44:47], v[124:127], v[148:151], v[44:47]
    buffer_load_dwordx4 v[124:127], v224, s[28:31], s82 offen offset:2048 sc1
    v_mfma_f32_16x16x32_bf16 v[48:51], v[128:131], v[136:139], v[48:51]
    v_mfma_f32_16x16x32_bf16 v[52:55], v[128:131], v[140:143], v[52:55]
    v_mfma_f32_16x16x32_bf16 v[56:59], v[128:131], v[144:147], v[56:59]
    v_mfma_f32_16x16x32_bf16 v[60:63], v[128:131], v[148:151], v[60:63]
    buffer_load_dwordx4 v[128:131], v224, s[28:31], s82 offen offset:3072 sc1
    v_mfma_f32_16x16x32_bf16 v[64:67], v[132:135], v[136:139], v[64:67]
    buffer_load_dwordx4 v[136:139], v224, s[28:31], s81 offen offset:0 sc1
    v_mfma_f32_16x16x32_bf16 v[68:71], v[132:135], v[140:143], v[68:71]
    buffer_load_dwordx4 v[140:143], v224, s[28:31], s81 offen offset:1024 sc1
    v_mfma_f32_16x16x32_bf16 v[72:75], v[132:135], v[144:147], v[72:75]
    buffer_load_dwordx4 v[144:147], v224, s[28:31], s81 offen offset:2048 sc1
    v_mfma_f32_16x16x32_bf16 v[76:79], v[132:135], v[148:151], v[76:79]
    buffer_load_dwordx4 v[148:151], v224, s[28:31], s81 offen offset:3072 sc1
    buffer_load_dwordx4 v[132:135], v225, s[28:31], s82 offen offset:0 sc1
    s_add_u32 s82, s82, 5120
    s_add_u32 s81, s81, 4096
    s_waitcnt vmcnt(27)
    v_mfma_f32_16x16x32_bf16 v[0:3], v[152:155], v[172:175], v[0:3]
    v_mfma_f32_16x16x32_bf16 v[4:7], v[152:155], v[176:179], v[4:7]
    v_mfma_f32_16x16x32_bf16 v[8:11], v[152:155], v[180:183], v[8:11]
    v_mfma_f32_16x16x32_bf16 v[12:15], v[152:155], v[184:187], v[12:15]
    buffer_load_dwordx4 v[152:155], v224, s[28:31], s82 offen offset:0 sc1
    v_mfma_f32_16x16x32_bf16 v[16:19], v[156:159], v[172:175], v[16:19]
    v_mfma_f32_16x16x32_bf16 v[20:23], v[156:159], v[176:179], v[20:23]
    v_mfma_f32_16x16x32_bf16 v[24:27], v[156:159], v[180:183], v[24:27]
    v_mfma_f32_16x16x32_bf16 v[28:31], v[156:159], v[184:187], v[28:31]
    buffer_load_dwordx4 v[156:159], v224, s[28:31], s82 offen offset:1024 sc1
    v_mfma_f32_16x16x32_bf16 v[32:35], v[160:163], v[172:175], v[32:35]
    v_mfma_f32_16x16x32_bf16 v[36:39], v[160:163], v[176:179], v[36:39]
    v_mfma_f32_16x16x32_bf16 v[40:43], v[160:163], v[180:183], v[40:43]
    v_mfma_f32_16x16x32_bf16 v[44:47], v[160:163], v[184:187], v[44:47]
    buffer_load_dwordx4 v[160:163], v224, s[28:31], s82 offen offset:2048 sc1
    v_mfma_f32_16x16x32_bf16 v[48:51], v[164:167], v[172:175], v[48:51]
    v_mfma_f32_16x16x32_bf16 v[52:55], v[164:167], v[176:179], v[52:55]
    v_mfma_f32_16x16x32_bf16 v[56:59], v[164:167], v[180:183], v[56:59]
    v_mfma_f32_16x16x32_bf16 v[60:63], v[164:167], v[184:187], v[60:63]
    buffer_load_dwordx4 v[164:167], v224, s[28:31], s82 offen offset:3072 sc1
    v_mfma_f32_16x16x32_bf16 v[64:67], v[168:171], v[172:175], v[64:67]
    buffer_load_dwordx4 v[172:175], v224, s[28:31], s81 offen offset:0 sc1
    v_mfma_f32_16x16x32_bf16 v[68:71], v[168:171], v[176:179], v[68:71]
    buffer_load_dwordx4 v[176:179], v224, s[28:31], s81 offen offset:1024 sc1
    v_mfma_f32_16x16x32_bf16 v[72:75], v[168:171], v[180:183], v[72:75]
    buffer_load_dwordx4 v[180:183], v224, s[28:31], s81 offen offset:2048 sc1
    v_mfma_f32_16x16x32_bf16 v[76:79], v[168:171], v[184:187], v[76:79]
    buffer_load_dwordx4 v[184:187], v224, s[28:31], s81 offen offset:3072 sc1
    buffer_load_dwordx4 v[168:171], v225, s[28:31], s82 offen offset:0 sc1
    s_add_u32 s82, s82, 5120
    s_add_u32 s81, s81, 4096
    s_waitcnt vmcnt(27)
    v_mfma_f32_16x16x32_bf16 v[0:3], v[188:191], v[208:211], v[0:3]
    v_mfma_f32_16x16x32_bf16 v[4:7], v[188:191], v[212:215], v[4:7]
    v_mfma_f32_16x16x32_bf16 v[8:11], v[188:191], v[216:219], v[8:11]
    v_mfma_f32_16x16x32_bf16 v[12:15], v[188:191], v[220:223], v[12:15]
    buffer_load_dwordx4 v[188:191], v224, s[28:31], s82 offen offset:0 sc1
    v_mfma_f32_16x16x32_bf16 v[16:19], v[192:195], v[208:211], v[16:19]
    v_mfma_f32_16x16x32_bf16 v[20:23], v[192:195], v[212:215], v[20:23]
    v_mfma_f32_16x16x32_bf16 v[24:27], v[192:195], v[216:219], v[24:27]
    v_mfma_f32_16x16x32_bf16 v[28:31], v[192:195], v[220:223], v[28:31]
    buffer_load_dwordx4 v[192:195], v224, s[28:31], s82 offen offset:1024 sc1
    v_mfma_f32_16x16x32_bf16 v[32:35], v[196:199], v[208:211], v[32:35]
    v_mfma_f32_16x16x32_bf16 v[36:39], v[196:199], v[212:215], v[36:39]
    v_mfma_f32_16x16x32_bf16 v[40:43], v[196:199], v[216:219], v[40:43]
    v_mfma_f32_16x16x32_bf16 v[44:47], v[196:199], v[220:223], v[44:47]
    buffer_load_dwordx4 v[196:199], v224, s[28:31], s82 offen offset:2048 sc1
    v_mfma_f32_16x16x32_bf16 v[48:51], v[200:203], v[208:211], v[48:51]
    v_mfma_f32_16x16x32_bf16 v[52:55], v[200:203], v[212:215], v[52:55]
    v_mfma_f32_16x16x32_bf16 v[56:59], v[200:203], v[216:219], v[56:59]
    v_mfma_f32_16x16x32_bf16 v[60:63], v[200:203], v[220:223], v[60:63]
    buffer_load_dwordx4 v[200:203], v224, s[28:31], s82 offen offset:3072 sc1
    v_mfma_f32_16x16x32_bf16 v[64:67], v[204:207], v[208:211], v[64:67]
    buffer_load_dwordx4 v[208:211], v224, s[28:31], s81 offen offset:0 sc1
    v_mfma_f32_16x16x32_bf16 v[68:71], v[204:207], v[212:215], v[68:71]
    buffer_load_dwordx4 v[212:215], v224, s[28:31], s81 offen offset:1024 sc1
    v_mfma_f32_16x16x32_bf16 v[72:75], v[204:207], v[216:219], v[72:75]
    buffer_load_dwordx4 v[216:219], v224, s[28:31], s81 offen offset:2048 sc1
    v_mfma_f32_16x16x32_bf16 v[76:79], v[204:207], v[220:223], v[76:79]
    buffer_load_dwordx4 v[220:223], v224, s[28:31], s81 offen offset:3072 sc1
    buffer_load_dwordx4 v[204:207], v225, s[28:31], s82 offen offset:0 sc1
    s_add_u32 s82, s82, 5120
    s_add_u32 s81, s81, 4096
    s_sub_u32 s60, s60, 1
    s_cmp_lg_u32 s60, 0
    s_cbranch_scc1 L_gl
    s_cmp_lg_u32 s4, 0
    s_cbranch_scc1 L_g4
    s_add_u32 s81, s81, 245760
    s_add_u32 s82, s82, 307200
    v_or_b32 v226, 388, v226
    s_waitcnt vmcnt(27)
    v_mfma_f32_16x16x32_bf16 v[0:3], v[80:83], v[100:103], v[0:3]
    v_mfma_f32_16x16x32_bf16 v[4:7], v[80:83], v[104:107], v[4:7]
    v_mfma_f32_16x16x32_bf16 v[8:11], v[80:83], v[108:111], v[8:11]
    v_mfma_f32_16x16x32_bf16 v[12:15], v[80:83], v[112:115], v[12:15]
    buffer_load_dwordx4 v[80:83], v224, s[28:31], s82 offen offset:0 sc1
    v_mfma_f32_16x16x32_bf16 v[16:19], v[84:87], v[100:103], v[16:19]
    v_mfma_f32_16x16x32_bf16 v[20:23], v[84:87], v[104:107], v[20:23]
    v_mfma_f32_16x16x32_bf16 v[24:27], v[84:87], v[108:111], v[24:27]
    v_mfma_f32_16x16x32_bf16 v[28:31], v[84:87], v[112:115], v[28:31]
    buffer_load_dwordx4 v[84:87], v224, s[28:31], s82 offen offset:1024 sc1
    v_mfma_f32_16x16x32_bf16 v[32:35], v[88:91], v[100:103], v[32:35]
    v_mfma_f32_16x16x32_bf16 v[36:39], v[88:91], v[104:107], v[36:39]
    v_mfma_f32_16x16x32_bf16 v[40:43], v[88:91], v[108:111], v[40:43]
    v_mfma_f32_16x16x32_bf16 v[44:47], v[88:91], v[112:115], v[44:47]
    buffer_load_dwordx4 v[88:91], v224, s[28:31], s82 offen offset:2048 sc1
    v_mfma_f32_16x16x32_bf16 v[48:51], v[92:95], v[100:103], v[48:51]
    v_mfma_f32_16x16x32_bf16 v[52:55], v[92:95], v[104:107], v[52:55]
    v_mfma_f32_16x16x32_bf16 v[56:59], v[92:95], v[108:111], v[56:59]
    v_mfma_f32_16x16x32_bf16 v[60:63], v[92:95], v[112:115], v[60:63]
    buffer_load_dwordx4 v[92:95], v224, s[28:31], s82 offen offset:3072 sc1
    v_mfma_f32_16x16x32_bf16 v[64:67], v[96:99], v[100:103], v[64:67]
    v_mfma_f32_16x16x32_bf16 v[68:71], v[96:99], v[104:107], v[68:71]
    v_mfma_f32_16x16x32_bf16 v[72:75], v[96:99], v[108:111], v[72:75]
    v_mfma_f32_16x16x32_bf16 v[76:79], v[96:99], v[112:115], v[76:79]
    buffer_load_dwordx4 v[96:99], v225, s[28:31], s82 offen offset:0 sc1
    s_add_u32 s82, s82, 5120
    s_waitcnt vmcnt(23)
    v_mfma_f32_16x16x32_bf16 v[0:3], v[116:119], v[136:139], v[0:3]
    v_mfma_f32_16x16x32_bf16 v[4:7], v[116:119], v[140:143], v[4:7]
    v_mfma_f32_16x16x32_bf16 v[8:11], v[116:119], v[144:147], v[8:11]
    v_mfma_f32_16x16x32_bf16 v[12:15], v[116:119], v[148:151], v[12:15]
    buffer_load_dwordx4 v[116:119], v224, s[28:31], s82 offen offset:0 sc1
    v_mfma_f32_16x16x32_bf16 v[16:19], v[120:123], v[136:139], v[16:19]
    v_mfma_f32_16x16x32_bf16 v[20:23], v[120:123], v[140:143], v[20:23]
    v_mfma_f32_16x16x32_bf16 v[24:27], v[120:123], v[144:147], v[24:27]
    v_mfma_f32_16x16x32_bf16 v[28:31], v[120:123], v[148:151], v[28:31]
    buffer_load_dwordx4 v[120:123], v224, s[28:31], s82 offen offset:1024 sc1
    v_mfma_f32_16x16x32_bf16 v[32:35], v[124:127], v[136:139], v[32:35]
    v_mfma_f32_16x16x32_bf16 v[36:39], v[124:127], v[140:143], v[36:39]
    v_mfma_f32_16x16x32_bf16 v[40:43], v[124:127], v[144:147], v[40:43]
    v_mfma_f32_16x16x32_bf16 v[44:47], v[124:127], v[148:151], v[44:47]
    buffer_load_dwordx4 v[124:127], v224, s[28:31], s82 offen offset:2048 sc1
    v_mfma_f32_16x16x32_bf16 v[48:51], v[128:131], v[136:139], v[48:51]
    v_mfma_f32_16x16x32_bf16 v[52:55], v[128:131], v[140:143], v[52:55]
    v_mfma_f32_16x16x32_bf16 v[56:59], v[128:131], v[144:147], v[56:59]
    v_mfma_f32_16x16x32_bf16 v[60:63], v[128:131], v[148:151], v[60:63]
    buffer_load_dwordx4 v[128:131], v224, s[28:31], s82 offen offset:3072 sc1
    v_mfma_f32_16x16x32_bf16 v[64:67], v[132:135], v[136:139], v[64:67]
    v_mfma_f32_16x16x32_bf16 v[68:71], v[132:135], v[140:143], v[68:71]
    v_mfma_f32_16x16x32_bf16 v[72:75], v[132:135], v[144:147], v[72:75]
    v_mfma_f32_16x16x32_bf16 v[76:79], v[132:135], v[148:151], v[76:79]
    buffer_load_dwordx4 v[132:135], v225, s[28:31], s82 offen offset:0 sc1
    s_add_u32 s82, s82, 5120
    s_waitcnt vmcnt(19)
    v_mfma_f32_16x16x32_bf16 v[0:3], v[152:155], v[172:175], v[0:3]
    v_mfma_f32_16x16x32_bf16 v[4:7], v[152:155], v[176:179], v[4:7]
    v_mfma_f32_16x16x32_bf16 v[8:11], v[152:155], v[180:183], v[8:11]
    v_mfma_f32_16x16x32_bf16 v[12:15], v[152:155], v[184:187], v[12:15]
    buffer_load_dwordx4 v[152:155], v224, s[28:31], s82 offen offset:0 sc1
    v_mfma_f32_16x16x32_bf16 v[16:19], v[156:159], v[172:175], v[16:19]
    v_mfma_f32_16x16x32_bf16 v[20:23], v[156:159], v[176:179], v[20:23]
    v_mfma_f32_16x16x32_bf16 v[24:27], v[156:159], v[180:183], v[24:27]
    v_mfma_f32_16x16x32_bf16 v[28:31], v[156:159], v[184:187], v[28:31]
    buffer_load_dwordx4 v[156:159], v224, s[28:31], s82 offen offset:1024 sc1
    v_mfma_f32_16x16x32_bf16 v[32:35], v[160:163], v[172:175], v[32:35]
    v_mfma_f32_16x16x32_bf16 v[36:39], v[160:163], v[176:179], v[36:39]
    v_mfma_f32_16x16x32_bf16 v[40:43], v[160:163], v[180:183], v[40:43]
    v_mfma_f32_16x16x32_bf16 v[44:47], v[160:163], v[184:187], v[44:47]
    buffer_load_dwordx4 v[160:163], v224, s[28:31], s82 offen offset:2048 sc1
    v_mfma_f32_16x16x32_bf16 v[48:51], v[164:167], v[172:175], v[48:51]
    v_mfma_f32_16x16x32_bf16 v[52:55], v[164:167], v[176:179], v[52:55]
    v_mfma_f32_16x16x32_bf16 v[56:59], v[164:167], v[180:183], v[56:59]
    v_mfma_f32_16x16x32_bf16 v[60:63], v[164:167], v[184:187], v[60:63]
    buffer_load_dwordx4 v[164:167], v224, s[28:31], s82 offen offset:3072 sc1
    v_mfma_f32_16x16x32_bf16 v[64:67], v[168:171], v[172:175], v[64:67]
    v_mfma_f32_16x16x32_bf16 v[68:71], v[168:171], v[176:179], v[68:71]
    v_mfma_f32_16x16x32_bf16 v[72:75], v[168:171], v[180:183], v[72:75]
    v_mfma_f32_16x16x32_bf16 v[76:79], v[168:171], v[184:187], v[76:79]
    buffer_load_dwordx4 v[168:171], v225, s[28:31], s82 offen offset:0 sc1
    s_add_u32 s82, s82, 5120
    s_waitcnt vmcnt(15)
    v_mfma_f32_16x16x32_bf16 v[0:3], v[188:191], v[208:211], v[0:3]
    v_mfma_f32_16x16x32_bf16 v[4:7], v[188:191], v[212:215], v[4:7]
    v_mfma_f32_16x16x32_bf16 v[8:11], v[188:191], v[216:219], v[8:11]
    v_mfma_f32_16x16x32_bf16 v[12:15], v[188:191], v[220:223], v[12:15]
    buffer_load_dwordx4 v[188:191], v224, s[28:31], s82 offen offset:0 sc1
    v_mfma_f32_16x16x32_bf16 v[16:19], v[192:195], v[208:211], v[16:19]
    v_mfma_f32_16x16x32_bf16 v[20:23], v[192:195], v[212:215], v[20:23]
    v_mfma_f32_16x16x32_bf16 v[24:27], v[192:195], v[216:219], v[24:27]
    v_mfma_f32_16x16x32_bf16 v[28:31], v[192:195], v[220:223], v[28:31]
    buffer_load_dwordx4 v[192:195], v224, s[28:31], s82 offen offset:1024 sc1
    v_mfma_f32_16x16x32_bf16 v[32:35], v[196:199], v[208:211], v[32:35]
    v_mfma_f32_16x16x32_bf16 v[36:39], v[196:199], v[212:215], v[36:39]
    v_mfma_f32_16x16x32_bf16 v[40:43], v[196:199], v[216:219], v[40:43]
    v_mfma_f32_16x16x32_bf16 v[44:47], v[196:199], v[220:223], v[44:47]
    buffer_load_dwordx4 v[196:199], v224, s[28:31], s82 offen offset:2048 sc1
    v_mfma_f32_16x16x32_bf16 v[48:51], v[200:203], v[208:211], v[48:51]
    v_mfma_f32_16x16x32_bf16 v[52:55], v[200:203], v[212:215], v[52:55]
    v_mfma_f32_16x16x32_bf16 v[56:59], v[200:203], v[216:219], v[56:59]
    v_mfma_f32_16x16x32_bf16 v[60:63], v[200:203], v[220:223], v[60:63]
    buffer_load_dwordx4 v[200:203], v224, s[28:31], s82 offen offset:3072 sc1
    v_mfma_f32_16x16x32_bf16 v[64:67], v[204:207], v[208:211], v[64:67]
    v_mfma_f32_16x16x32_bf16 v[68:71], v[204:207], v[212:215], v[68:71]
    v_mfma_f32_16x16x32_bf16 v[72:75], v[204:207], v[216:219], v[72:75]
    v_mfma_f32_16x16x32_bf16 v[76:79], v[204:207], v[220:223], v[76:79]
    buffer_load_dwordx4 v[204:207], v225, s[28:31], s82 offen offset:0 sc1
    s_add_u32 s82, s82, 5120
    s_mov_b32 s67, 0x40000
L_q:
    buffer_load_dword v253, v226, s[28:31], 0 offen sc1
    s_waitcnt vmcnt(0)
    v_cmp_gt_u32 vcc, 1, v253
    s_sub_u32 s67, s67, 1
    s_cbranch_scc1 L_q_x
    s_cbranch_vccnz L_q
L_q_x:
    buffer_load_dwordx4 v[100:103], v224, s[28:31], s81 offen offset:0 sc1
    buffer_load_dwordx4 v[104:107], v224, s[28:31], s81 offen offset:1024 sc1
    buffer_load_dwordx4 v[108:111], v224, s[28:31], s81 offen offset:2048 sc1
    buffer_load_dwordx4 v[112:115], v224, s[28:31], s81 offen offset:3072 sc1
    s_add_u32 s81, s81, 4096
    buffer_load_dwordx4 v[136:139], v224, s[28:31], s81 offen offset:0 sc1
    buffer_load_dwordx4 v[140:143], v224, s[28:31], s81 offen offset:1024 sc1
    buffer_load_dwordx4 v[144:147], v224, s[28:31], s81 offen offset:2048 sc1
    buffer_load_dwordx4 v[148:151], v224, s[28:31], s81 offen offset:3072 sc1
    s_add_u32 s81, s81, 4096
    buffer_load_dwordx4 v[172:175], v224, s[28:31], s81 offen offset:0 sc1
    buffer_load_dwordx4 v[176:179], v224, s[28:31], s81 offen offset:1024 sc1
    buffer_load_dwordx4 v[180:183], v224, s[28:31], s81 offen offset:2048 sc1
    buffer_load_dwordx4 v[184:187], v224, s[28:31], s81 offen offset:3072 sc1
    s_add_u32 s81, s81, 4096
    buffer_load_dwordx4 v[208:211], v224, s[28:31], s81 offen offset:0 sc1
    buffer_load_dwordx4 v[212:215], v224, s[28:31], s81 offen offset:1024 sc1
    buffer_load_dwordx4 v[216:219], v224, s[28:31], s81 offen offset:2048 sc1
    buffer_load_dwordx4 v[220:223], v224, s[28:31], s81 offen offset:3072 sc1
    s_add_u32 s81, s81, 4096
    s_waitcnt vmcnt(12)
    v_mfma_f32_16x16x32_bf16 v[0:3], v[80:83], v[100:103], v[0:3]
    v_mfma_f32_16x16x32_bf16 v[4:7], v[80:83], v[104:107], v[4:7]
    v_mfma_f32_16x16x32_bf16 v[8:11], v[80:83], v[108:111], v[8:11]
    v_mfma_f32_16x16x32_bf16 v[12:15], v[80:83], v[112:115], v[12:15]
    v_mfma_f32_16x16x32_bf16 v[16:19], v[84:87], v[100:103], v[16:19]
    v_mfma_f32_16x16x32_bf16 v[20:23], v[84:87], v[104:107], v[20:23]
    v_mfma_f32_16x16x32_bf16 v[24:27], v[84:87], v[108:111], v[24:27]
    v_mfma_f32_16x16x32_bf16 v[28:31], v[84:87], v[112:115], v[28:31]
    v_mfma_f32_16x16x32_bf16 v[32:35], v[88:91], v[100:103], v[32:35]
    v_mfma_f32_16x16x32_bf16 v[36:39], v[88:91], v[104:107], v[36:39]
    v_mfma_f32_16x16x32_bf16 v[40:43], v[88:91], v[108:111], v[40:43]
    v_mfma_f32_16x16x32_bf16 v[44:47], v[88:91], v[112:115], v[44:47]
    v_mfma_f32_16x16x32_bf16 v[48:51], v[92:95], v[100:103], v[48:51]
    v_mfma_f32_16x16x32_bf16 v[52:55], v[92:95], v[104:107], v[52:55]
    v_mfma_f32_16x16x32_bf16 v[56:59], v[92:95], v[108:111], v[56:59]
    v_mfma_f32_16x16x32_bf16 v[60:63], v[92:95], v[112:115], v[60:63]
    v_mfma_f32_16x16x32_bf16 v[64:67], v[96:99], v[100:103], v[64:67]
    v_mfma_f32_16x16x32_bf16 v[68:71], v[96:99], v[104:107], v[68:71]
    v_mfma_f32_16x16x32_bf16 v[72:75], v[96:99], v[108:111], v[72:75]
    v_mfma_f32_16x16x32_bf16 v[76:79], v[96:99], v[112:115], v[76:79]
    s_waitcnt vmcnt(8)
    v_mfma_f32_16x16x32_bf16 v[0:3], v[116:119], v[136:139], v[0:3]
    v_mfma_f32_16x16x32_bf16 v[4:7], v[116:119], v[140:143], v[4:7]
    v_mfma_f32_16x16x32_bf16 v[8:11], v[116:119], v[144:147], v[8:11]
    v_mfma_f32_16x16x32_bf16 v[12:15], v[116:119], v[148:151], v[12:15]
    v_mfma_f32_16x16x32_bf16 v[16:19], v[120:123], v[136:139], v[16:19]
    v_mfma_f32_16x16x32_bf16 v[20:23], v[120:123], v[140:143], v[20:23]
    v_mfma_f32_16x16x32_bf16 v[24:27], v[120:123], v[144:147], v[24:27]
    v_mfma_f32_16x16x32_bf16 v[28:31], v[120:123], v[148:151], v[28:31]
    v_mfma_f32_16x16x32_bf16 v[32:35], v[124:127], v[136:139], v[32:35]
    v_mfma_f32_16x16x32_bf16 v[36:39], v[124:127], v[140:143], v[36:39]
    v_mfma_f32_16x16x32_bf16 v[40:43], v[124:127], v[144:147], v[40:43]
    v_mfma_f32_16x16x32_bf16 v[44:47], v[124:127], v[148:151], v[44:47]
    v_mfma_f32_16x16x32_bf16 v[48:51], v[128:131], v[136:139], v[48:51]
    v_mfma_f32_16x16x32_bf16 v[52:55], v[128:131], v[140:143], v[52:55]
    v_mfma_f32_16x16x32_bf16 v[56:59], v[128:131], v[144:147], v[56:59]
    v_mfma_f32_16x16x32_bf16 v[60:63], v[128:131], v[148:151], v[60:63]
    v_mfma_f32_16x16x32_bf16 v[64:67], v[132:135], v[136:139], v[64:67]
    v_mfma_f32_16x16x32_bf16 v[68:71], v[132:135], v[140:143], v[68:71]
    v_mfma_f32_16x16x32_bf16 v[72:75], v[132:135], v[144:147], v[72:75]
    v_mfma_f32_16x16x32_bf16 v[76:79], v[132:135], v[148:151], v[76:79]
    s_waitcnt vmcnt(4)
    v_mfma_f32_16x16x32_bf16 v[0:3], v[152:155], v[172:175], v[0:3]
    v_mfma_f32_16x16x32_bf16 v[4:7], v[152:155], v[176:179], v[4:7]
    v_mfma_f32_16x16x32_bf16 v[8:11], v[152:155], v[180:183], v[8:11]
    v_mfma_f32_16x16x32_bf16 v[12:15], v[152:155], v[184:187], v[12:15]
    v_mfma_f32_16x16x32_bf16 v[16:19], v[156:159], v[172:175], v[16:19]
    v_mfma_f32_16x16x32_bf16 v[20:23], v[156:159], v[176:179], v[20:23]
    v_mfma_f32_16x16x32_bf16 v[24:27], v[156:159], v[180:183], v[24:27]
    v_mfma_f32_16x16x32_bf16 v[28:31], v[156:159], v[184:187], v[28:31]
    v_mfma_f32_16x16x32_bf16 v[32:35], v[160:163], v[172:175], v[32:35]
    v_mfma_f32_16x16x32_bf16 v[36:39], v[160:163], v[176:179], v[36:39]
    v_mfma_f32_16x16x32_bf16 v[40:43], v[160:163], v[180:183], v[40:43]
    v_mfma_f32_16x16x32_bf16 v[44:47], v[160:163], v[184:187], v[44:47]
    v_mfma_f32_16x16x32_bf16 v[48:51], v[164:167], v[172:175], v[48:51]
    v_mfma_f32_16x16x32_bf16 v[52:55], v[164:167], v[176:179], v[52:55]
    v_mfma_f32_16x16x32_bf16 v[56:59], v[164:167], v[180:183], v[56:59]
    v_mfma_f32_16x16x32_bf16 v[60:63], v[164:167], v[184:187], v[60:63]
    v_mfma_f32_16x16x32_bf16 v[64:67], v[168:171], v[172:175], v[64:67]
    v_mfma_f32_16x16x32_bf16 v[68:71], v[168:171], v[176:179], v[68:71]
    v_mfma_f32_16x16x32_bf16 v[72:75], v[168:171], v[180:183], v[72:75]
    v_mfma_f32_16x16x32_bf16 v[76:79], v[168:171], v[184:187], v[76:79]
    s_waitcnt vmcnt(0)
    v_mfma_f32_16x16x32_bf16 v[0:3], v[188:191], v[208:211], v[0:3]
    v_mfma_f32_16x16x32_bf16 v[4:7], v[188:191], v[212:215], v[4:7]
    v_mfma_f32_16x16x32_bf16 v[8:11], v[188:191], v[216:219], v[8:11]
    v_mfma_f32_16x16x32_bf16 v[12:15], v[188:191], v[220:223], v[12:15]
    v_mfma_f32_16x16x32_bf16 v[16:19], v[192:195], v[208:211], v[16:19]
    v_mfma_f32_16x16x32_bf16 v[20:23], v[192:195], v[212:215], v[20:23]
    v_mfma_f32_16x16x32_bf16 v[24:27], v[192:195], v[216:219], v[24:27]
    v_mfma_f32_16x16x32_bf16 v[28:31], v[192:195], v[220:223], v[28:31]
    v_mfma_f32_16x16x32_bf16 v[32:35], v[196:199], v[208:211], v[32:35]
    v_mfma_f32_16x16x32_bf16 v[36:39], v[196:199], v[212:215], v[36:39]
    v_mfma_f32_16x16x32_bf16 v[40:43], v[196:199], v[216:219], v[40:43]
    v_mfma_f32_16x16x32_bf16 v[44:47], v[196:199], v[220:223], v[44:47]
    v_mfma_f32_16x16x32_bf16 v[48:51], v[200:203], v[208:211], v[48:51]
    v_mfma_f32_16x16x32_bf16 v[52:55], v[200:203], v[212:215], v[52:55]
    v_mfma_f32_16x16x32_bf16 v[56:59], v[200:203], v[216:219], v[56:59]
    v_mfma_f32_16x16x32_bf16 v[60:63], v[200:203], v[220:223], v[60:63]
    v_mfma_f32_16x16x32_bf16 v[64:67], v[204:207], v[208:211], v[64:67]
    v_mfma_f32_16x16x32_bf16 v[68:71], v[204:207], v[212:215], v[68:71]
    v_mfma_f32_16x16x32_bf16 v[72:75], v[204:207], v[216:219], v[72:75]
    v_mfma_f32_16x16x32_bf16 v[76:79], v[204:207], v[220:223], v[76:79]
    s_branch L_red
L_g4:
    s_waitcnt vmcnt(27)
    v_mfma_f32_16x16x32_bf16 v[0:3], v[80:83], v[100:103], v[0:3]
    v_mfma_f32_16x16x32_bf16 v[4:7], v[80:83], v[104:107], v[4:7]
    v_mfma_f32_16x16x32_bf16 v[8:11], v[80:83], v[108:111], v[8:11]
    v_mfma_f32_16x16x32_bf16 v[12:15], v[80:83], v[112:115], v[12:15]
    v_mfma_f32_16x16x32_bf16 v[16:19], v[84:87], v[100:103], v[16:19]
    v_mfma_f32_16x16x32_bf16 v[20:23], v[84:87], v[104:107], v[20:23]
    v_mfma_f32_16x16x32_bf16 v[24:27], v[84:87], v[108:111], v[24:27]
    v_mfma_f32_16x16x32_bf16 v[28:31], v[84:87], v[112:115], v[28:31]
    v_mfma_f32_16x16x32_bf16 v[32:35], v[88:91], v[100:103], v[32:35]
    v_mfma_f32_16x16x32_bf16 v[36:39], v[88:91], v[104:107], v[36:39]
    v_mfma_f32_16x16x32_bf16 v[40:43], v[88:91], v[108:111], v[40:43]
    v_mfma_f32_16x16x32_bf16 v[44:47], v[88:91], v[112:115], v[44:47]
    v_mfma_f32_16x16x32_bf16 v[48:51], v[92:95], v[100:103], v[48:51]
    v_mfma_f32_16x16x32_bf16 v[52:55], v[92:95], v[104:107], v[52:55]
    v_mfma_f32_16x16x32_bf16 v[56:59], v[92:95], v[108:111], v[56:59]
    v_mfma_f32_16x16x32_bf16 v[60:63], v[92:95], v[112:115], v[60:63]
    v_mfma_f32_16x16x32_bf16 v[64:67], v[96:99], v[100:103], v[64:67]
    v_mfma_f32_16x16x32_bf16 v[68:71], v[96:99], v[104:107], v[68:71]
    v_mfma_f32_16x16x32_bf16 v[72:75], v[96:99], v[108:111], v[72:75]
    v_mfma_f32_16x16x32_bf16 v[76:79], v[96:99], v[112:115], v[76:79]
    s_waitcnt vmcnt(18)
    v_mfma_f32_16x16x32_bf16 v[0:3], v[116:119], v[136:139], v[0:3]
    v_mfma_f32_16x16x32_bf16 v[4:7], v[116:119], v[140:143], v[4:7]
    v_mfma_f32_16x16x32_bf16 v[8:11], v[116:119], v[144:147], v[8:11]
    v_mfma_f32_16x16x32_bf16 v[12:15], v[116:119], v[148:151], v[12:15]
    v_mfma_f32_16x16x32_bf16 v[16:19], v[120:123], v[136:139], v[16:19]
    v_mfma_f32_16x16x32_bf16 v[20:23], v[120:123], v[140:143], v[20:23]
    v_mfma_f32_16x16x32_bf16 v[24:27], v[120:123], v[144:147], v[24:27]
    v_mfma_f32_16x16x32_bf16 v[28:31], v[120:123], v[148:151], v[28:31]
    v_mfma_f32_16x16x32_bf16 v[32:35], v[124:127], v[136:139], v[32:35]
    v_mfma_f32_16x16x32_bf16 v[36:39], v[124:127], v[140:143], v[36:39]
    v_mfma_f32_16x16x32_bf16 v[40:43], v[124:127], v[144:147], v[40:43]
    v_mfma_f32_16x16x32_bf16 v[44:47], v[124:127], v[148:151], v[44:47]
    v_mfma_f32_16x16x32_bf16 v[48:51], v[128:131], v[136:139], v[48:51]
    v_mfma_f32_16x16x32_bf16 v[52:55], v[128:131], v[140:143], v[52:55]
    v_mfma_f32_16x16x32_bf16 v[56:59], v[128:131], v[144:147], v[56:59]
    v_mfma_f32_16x16x32_bf16 v[60:63], v[128:131], v[148:151], v[60:63]
    v_mfma_f32_16x16x32_bf16 v[64:67], v[132:135], v[136:139], v[64:67]
    v_mfma_f32_16x16x32_bf16 v[68:71], v[132:135], v[140:143], v[68:71]
    v_mfma_f32_16x16x32_bf16 v[72:75], v[132:135], v[144:147], v[72:75]
    v_mfma_f32_16x16x32_bf16 v[76:79], v[132:135], v[148:151], v[76:79]
    s_waitcnt vmcnt(9)
    v_mfma_f32_16x16x32_bf16 v[0:3], v[152:155], v[172:175], v[0:3]
    v_mfma_f32_16x16x32_bf16 v[4:7], v[152:155], v[176:179], v[4:7]
    v_mfma_f32_16x16x32_bf16 v[8:11], v[152:155], v[180:183], v[8:11]
    v_mfma_f32_16x16x32_bf16 v[12:15], v[152:155], v[184:187], v[12:15]
    v_mfma_f32_16x16x32_bf16 v[16:19], v[156:159], v[172:175], v[16:19]
    v_mfma_f32_16x16x32_bf16 v[20:23], v[156:159], v[176:179], v[20:23]
    v_mfma_f32_16x16x32_bf16 v[24:27], v[156:159], v[180:183], v[24:27]
    v_mfma_f32_16x16x32_bf16 v[28:31], v[156:159], v[184:187], v[28:31]
    v_mfma_f32_16x16x32_bf16 v[32:35], v[160:163], v[172:175], v[32:35]
    v_mfma_f32_16x16x32_bf16 v[36:39], v[160:163], v[176:179], v[36:39]
    v_mfma_f32_16x16x32_bf16 v[40:43], v[160:163], v[180:183], v[40:43]
    v_mfma_f32_16x16x32_bf16 v[44:47], v[160:163], v[184:187], v[44:47]
    v_mfma_f32_16x16x32_bf16 v[48:51], v[164:167], v[172:175], v[48:51]
    v_mfma_f32_16x16x32_bf16 v[52:55], v[164:167], v[176:179], v[52:55]
    v_mfma_f32_16x16x32_bf16 v[56:59], v[164:167], v[180:183], v[56:59]
    v_mfma_f32_16x16x32_bf16 v[60:63], v[164:167], v[184:187], v[60:63]
    v_mfma_f32_16x16x32_bf16 v[64:67], v[168:171], v[172:175], v[64:67]
    v_mfma_f32_16x16x32_bf16 v[68:71], v[168:171], v[176:179], v[68:71]
    v_mfma_f32_16x16x32_bf16 v[72:75], v[168:171], v[180:183], v[72:75]
    v_mfma_f32_16x16x32_bf16 v[76:79], v[168:171], v[184:187], v[76:79]
    s_waitcnt vmcnt(0)
    v_mfma_f32_16x16x32_bf16 v[0:3], v[188:191], v[208:211], v[0:3]
    v_mfma_f32_16x16x32_bf16 v[4:7], v[188:191], v[212:215], v[4:7]
    v_mfma_f32_16x16x32_bf16 v[8:11], v[188:191], v[216:219], v[8:11]
    v_mfma_f32_16x16x32_bf16 v[12:15], v[188:191], v[220:223], v[12:15]
    v_mfma_f32_16x16x32_bf16 v[16:19], v[192:195], v[208:211], v[16:19]
    v_mfma_f32_16x16x32_bf16 v[20:23], v[192:195], v[212:215], v[20:23]
    v_mfma_f32_16x16x32_bf16 v[24:27], v[192:195], v[216:219], v[24:27]
    v_mfma_f32_16x16x32_bf16 v[28:31], v[192:195], v[220:223], v[28:31]
    v_mfma_f32_16x16x32_bf16 v[32:35], v[196:199], v[208:211], v[32:35]
    v_mfma_f32_16x16x32_bf16 v[36:39], v[196:199], v[212:215], v[36:39]
    v_mfma_f32_16x16x32_bf16 v[40:43], v[196:199], v[216:219], v[40:43]
    v_mfma_f32_16x16x32_bf16 v[44:47], v[196:199], v[220:223], v[44:47]
    v_mfma_f32_16x16x32_bf16 v[48:51], v[200:203], v[208:211], v[48:51]
    v_mfma_f32_16x16x32_bf16 v[52:55], v[200:203], v[212:215], v[52:55]
    v_mfma_f32_16x16x32_bf16 v[56:59], v[200:203], v[216:219], v[56:59]
    v_mfma_f32_16x16x32_bf16 v[60:63], v[200:203], v[220:223], v[60:63]
    v_mfma_f32_16x16x32_bf16 v[64:67], v[204:207], v[208:211], v[64:67]
    v_mfma_f32_16x16x32_bf16 v[68:71], v[204:207], v[212:215], v[68:71]
    v_mfma_f32_16x16x32_bf16 v[72:75], v[204:207], v[216:219], v[72:75]
    v_mfma_f32_16x16x32_bf16 v[76:79], v[204:207], v[220:223], v[76:79]
L_red:
    s_xor_b32 s66, s33, 4
    s_mul_i32 s66, s66, 20480
    v_add_u32 v250, s66, v224
    ds_write_b128 v250, v[0:3] offset:0
    ds_write_b128 v250, v[16:19] offset:1024
    ds_write_b128 v250, v[32:35] offset:2048
    ds_write_b128 v250, v[48:51] offset:3072
    ds_write_b128 v250, v[64:67] offset:4096
    ds_write_b128 v250, v[4:7] offset:5120
    ds_write_b128 v250, v[20:23] offset:6144
    ds_write_b128 v250, v[36:39] offset:7168
    ds_write_b128 v250, v[52:55] offset:8192
    ds_write_b128 v250, v[68:71] offset:9216
    ds_write_b128 v250, v[8:11] offset:10240
    ds_write_b128 v250, v[24:27] offset:11264
    ds_write_b128 v250, v[40:43] offset:12288
    ds_write_b128 v250, v[56:59] offset:13312
    ds_write_b128 v250, v[72:75] offset:14336
    s_waitcnt lgkmcnt(14)
    ds_write_b128 v250, v[12:15] offset:15360
    s_waitcnt lgkmcnt(14)
    ds_write_b128 v250, v[28:31] offset:16384
    s_waitcnt lgkmcnt(14)
    ds_write_b128 v250, v[44:47] offset:17408
    s_waitcnt lgkmcnt(14)
    ds_write_b128 v250, v[60:63] offset:18432
    s_waitcnt lgkmcnt(14)
    ds_write_b128 v250, v[76:79] offset:19456
    s_mul_i32 s66, s3, 5120
    s_mul_i32 s67, s4, 2048
    s_add_u32 s66, s66, s67
    v_add_u32 v250, s66, v224
    v_add_u32 v251, 61440, v250
    v_add_u32 v252, 122880, v250
    v_and_b32 v225, 15, v249
    v_mul_u32_u24 v225, 1280, v225
    v_lshrrev_b32 v226, 4, v249
    v_lshl_add_u32 v225, v226, 3, v225
    s_lshl_b32 s83, s83, 2
    s_add_u32 s83, s83, s3
    s_mul_i32 s83, s83, 20480
    s_mul_i32 s84, s84, 160
    s_add_u32 s83, s83, s84
    s_lshl_b32 s67, s4, 6
    s_add_u32 s83, s83, s67
    s_mov_b32 s16, s46
    s_mov_b32 s17, s47
    s_mov_b32 s18, 2621440
    s_mov_b32 s19, 0x20000
    s_waitcnt lgkmcnt(0)
    s_barrier
    ds_read_b128 v[80:83], v250 offset:0
    ds_read_b128 v[84:87], v250 offset:20480
    ds_read_b128 v[88:91], v250 offset:40960
    ds_read_b128 v[92:95], v251 offset:0
    ds_read_b128 v[96:99], v251 offset:20480
    ds_read_b128 v[100:103], v251 offset:40960
    ds_read_b128 v[104:107], v252 offset:0
    ds_read_b128 v[108:111], v252 offset:20480
    ds_read_b128 v[112:115], v250 offset:1024
    ds_read_b128 v[116:119], v250 offset:21504
    ds_read_b128 v[120:123], v250 offset:41984
    ds_read_b128 v[124:127], v251 offset:1024
    ds_read_b128 v[128:131], v251 offset:21504
    ds_read_b128 v[132:135], v251 offset:41984
    ds_read_b128 v[136:139], v252 offset:1024
    s_waitcnt lgkmcnt(14)
    ds_read_b128 v[140:143], v252 offset:21504
    s_waitcnt lgkmcnt(14)
    ds_read_b128 v[144:147], v250 offset:2048
    s_waitcnt lgkmcnt(14)
    ds_read_b128 v[148:151], v250 offset:22528
    s_waitcnt lgkmcnt(14)
    ds_read_b128 v[152:155], v250 offset:43008
    s_waitcnt lgkmcnt(14)
    ds_read_b128 v[156:159], v251 offset:2048
    s_waitcnt lgkmcnt(14)
    ds_read_b128 v[160:163], v251 offset:22528
    s_waitcnt lgkmcnt(14)
    ds_read_b128 v[164:167], v251 offset:43008
    s_waitcnt lgkmcnt(14)
    ds_read_b128 v[168:171], v252 offset:2048
    s_waitcnt lgkmcnt(14)
    ds_read_b128 v[172:175], v252 offset:22528
    v_add_f32 v80, v80, v96
    v_add_f32 v81, v81, v97
    v_add_f32 v82, v82, v98
    v_add_f32 v83, v83, v99
    v_add_f32 v84, v84, v100
    v_add_f32 v85, v85, v101
    v_add_f32 v86, v86, v102
    v_add_f32 v87, v87, v103
    v_add_f32 v88, v88, v104
    v_add_f32 v89, v89, v105
    v_add_f32 v90, v90, v106
    v_add_f32 v91, v91, v107
    v_add_f32 v92, v92, v108
    v_add_f32 v93, v93, v109
    v_add_f32 v94, v94, v110
    v_add_f32 v95, v95, v111
    v_add_f32 v80, v80, v88
    v_add_f32 v81, v81, v89
    v_add_f32 v82, v82, v90
    v_add_f32 v83, v83, v91
    v_add_f32 v84, v84, v92
    v_add_f32 v85, v85, v93
    v_add_f32 v86, v86, v94
    v_add_f32 v87, v87, v95
    v_add_f32 v80, v80, v84
    v_add_f32 v81, v81, v85
    v_add_f32 v82, v82, v86
    v_add_f32 v83, v83, v87
    v_cvt_pk_bf16_f32 v0, v80, v81
    v_cvt_pk_bf16_f32 v1, v82, v83
    buffer_store_dwordx2 v[0:1], v225, s[16:19], s83 offen offset:0
    s_waitcnt lgkmcnt(11)
    v_add_f32 v112, v112, v128
    v_add_f32 v113, v113, v129
    v_add_f32 v114, v114, v130
    v_add_f32 v115, v115, v131
    s_waitcnt lgkmcnt(10)
    v_add_f32 v116, v116, v132
    v_add_f32 v117, v117, v133
    v_add_f32 v118, v118, v134
    v_add_f32 v119, v119, v135
    s_waitcnt lgkmcnt(9)
    v_add_f32 v120, v120, v136
    v_add_f32 v121, v121, v137
    v_add_f32 v122, v122, v138
    v_add_f32 v123, v123, v139
    s_waitcnt lgkmcnt(8)
    v_add_f32 v124, v124, v140
    v_add_f32 v125, v125, v141
    v_add_f32 v126, v126, v142
    v_add_f32 v127, v127, v143
    v_add_f32 v112, v112, v120
    v_add_f32 v113, v113, v121
    v_add_f32 v114, v114, v122
    v_add_f32 v115, v115, v123
    v_add_f32 v116, v116, v124
    v_add_f32 v117, v117, v125
    v_add_f32 v118, v118, v126
    v_add_f32 v119, v119, v127
    v_add_f32 v112, v112, v116
    v_add_f32 v113, v113, v117
    v_add_f32 v114, v114, v118
    v_add_f32 v115, v115, v119
    v_cvt_pk_bf16_f32 v2, v112, v113
    v_cvt_pk_bf16_f32 v3, v114, v115
    buffer_store_dwordx2 v[2:3], v225, s[16:19], s83 offen offset:32
    s_waitcnt lgkmcnt(3)
    v_add_f32 v144, v144, v160
    v_add_f32 v145, v145, v161
    v_add_f32 v146, v146, v162
    v_add_f32 v147, v147, v163
    s_waitcnt lgkmcnt(2)
    v_add_f32 v148, v148, v164
    v_add_f32 v149, v149, v165
    v_add_f32 v150, v150, v166
    v_add_f32 v151, v151, v167
    s_waitcnt lgkmcnt(1)
    v_add_f32 v152, v152, v168
    v_add_f32 v153, v153, v169
    v_add_f32 v154, v154, v170
    v_add_f32 v155, v155, v171
    s_waitcnt lgkmcnt(0)
    v_add_f32 v156, v156, v172
    v_add_f32 v157, v157, v173
    v_add_f32 v158, v158, v174
    v_add_f32 v159, v159, v175
    v_add_f32 v144, v144, v152
    v_add_f32 v145, v145, v153
    v_add_f32 v146, v146, v154
    v_add_f32 v147, v147, v155
    v_add_f32 v148, v148, v156
    v_add_f32 v149, v149, v157
    v_add_f32 v150, v150, v158
    v_add_f32 v151, v151, v159
    v_add_f32 v144, v144, v148
    v_add_f32 v145, v145, v149
    v_add_f32 v146, v146, v150
    v_add_f32 v147, v147, v151
    v_cvt_pk_bf16_f32 v4, v144, v145
    v_cvt_pk_bf16_f32 v5, v146, v147
    buffer_store_dwordx2 v[4:5], v225, s[16:19], s83 offen offset:64
L_end:
    s_endpgm
L_resc_a:
    v_permlane32_swap_b32 v247, v248
    v_max_f32 v247, v247, v248
    v_mov_b32 v248, v247
    s_nop 1
    v_permlane16_swap_b32 v247, v248
    v_max_f32 v247, v247, v248
    v_max_f32 v247, 0, v247
    v_mov_b32 v250, v247
    v_mov_b32 v251, v247
    s_nop 1
    v_permlane32_swap_b32 v250, v251
    v_sub_f32 v236, v236, v250
    v_sub_f32 v237, v237, v250
    v_sub_f32 v238, v238, v250
    v_sub_f32 v239, v239, v250
    v_sub_f32 v96, v96, v250
    v_sub_f32 v97, v97, v250
    v_sub_f32 v98, v98, v250
    v_sub_f32 v99, v99, v250
    v_sub_f32 v100, v100, v250
    v_sub_f32 v101, v101, v250
    v_sub_f32 v102, v102, v250
    v_sub_f32 v103, v103, v250
    v_sub_f32 v112, v112, v250
    v_sub_f32 v113, v113, v250
    v_sub_f32 v114, v114, v250
    v_sub_f32 v115, v115, v250
    v_sub_f32 v116, v116, v250
    v_sub_f32 v117, v117, v250
    v_sub_f32 v118, v118, v250
    v_sub_f32 v119, v119, v250
    v_sub_f32 v240, v240, v251
    v_sub_f32 v241, v241, v251
    v_sub_f32 v242, v242, v251
    v_sub_f32 v243, v243, v251
    v_sub_f32 v104, v104, v251
    v_sub_f32 v105, v105, v251
    v_sub_f32 v106, v106, v251
    v_sub_f32 v107, v107, v251
    v_sub_f32 v108, v108, v251
    v_sub_f32 v109, v109, v251
    v_sub_f32 v110, v110, v251
    v_sub_f32 v111, v111, v251
    v_sub_f32 v120, v120, v251
    v_sub_f32 v121, v121, v251
    v_sub_f32 v122, v122, v251
    v_sub_f32 v123, v123, v251
    v_sub_f32 v124, v124, v251
    v_sub_f32 v125, v125, v251
    v_sub_f32 v126, v126, v251
    v_sub_f32 v127, v127, v251
    v_exp_f32 v250, -v250
    v_exp_f32 v251, -v251
    s_nop 0
    v_mul_f32 v245, v245, v250
    v_mul_f32 v246, v246, v251
    v_mul_f32 v0, v0, v250
    v_mul_f32 v1, v1, v250
    v_mul_f32 v2, v2, v250
    v_mul_f32 v3, v3, v250
    v_mul_f32 v4, v4, v251
    v_mul_f32 v5, v5, v251
    v_mul_f32 v6, v6, v251
    v_mul_f32 v7, v7, v251
    v_mul_f32 v8, v8, v250
    v_mul_f32 v9, v9, v250
    v_mul_f32 v10, v10, v250
    v_mul_f32 v11, v11, v250
    v_mul_f32 v12, v12, v251
    v_mul_f32 v13, v13, v251
    v_mul_f32 v14, v14, v251
    v_mul_f32 v15, v15, v251
    v_mul_f32 v16, v16, v250
    v_mul_f32 v17, v17, v250
    v_mul_f32 v18, v18, v250
    v_mul_f32 v19, v19, v250
    v_mul_f32 v20, v20, v251
    v_mul_f32 v21, v21, v251
    v_mul_f32 v22, v22, v251
    v_mul_f32 v23, v23, v251
    v_mul_f32 v24, v24, v250
    v_mul_f32 v25, v25, v250
    v_mul_f32 v26, v26, v250
    v_mul_f32 v27, v27, v250
    v_mul_f32 v28, v28, v251
    v_mul_f32 v29, v29, v251
    v_mul_f32 v30, v30, v251
    v_mul_f32 v31, v31, v251
    v_mul_f32 v32, v32, v250
    v_mul_f32 v33, v33, v250
    v_mul_f32 v34, v34, v250
    v_mul_f32 v35, v35, v250
    v_mul_f32 v36, v36, v251
    v_mul_f32 v37, v37, v251
    v_mul_f32 v38, v38, v251
    v_mul_f32 v39, v39, v251
    v_mul_f32 v40, v40, v250
    v_mul_f32 v41, v41, v250
    v_mul_f32 v42, v42, v250
    v_mul_f32 v43, v43, v250
    v_mul_f32 v44, v44, v251
    v_mul_f32 v45, v45, v251
    v_mul_f32 v46, v46, v251
    v_mul_f32 v47, v47, v251
    v_mul_f32 v48, v48, v250
    v_mul_f32 v49, v49, v250
    v_mul_f32 v50, v50, v250
    v_mul_f32 v51, v51, v250
    v_mul_f32 v52, v52, v251
    v_mul_f32 v53, v53, v251
    v_mul_f32 v54, v54, v251
    v_mul_f32 v55, v55, v251
    v_mul_f32 v56, v56, v250
    v_mul_f32 v57, v57, v250
    v_mul_f32 v58, v58, v250
    v_mul_f32 v59, v59, v250
    v_mul_f32 v60, v60, v251
    v_mul_f32 v61, v61, v251
    v_mul_f32 v62, v62, v251
    v_mul_f32 v63, v63, v251
    s_nop 1
    s_branch L_back_a
L_resc_b:
    v_permlane32_swap_b32 v247, v248
    v_max_f32 v247, v247, v248
    v_mov_b32 v248, v247
    s_nop 1
    v_permlane16_swap_b32 v247, v248
    v_max_f32 v247, v247, v248
    v_max_f32 v247, 0, v247
    v_mov_b32 v250, v247
    v_mov_b32 v251, v247
    s_nop 1
    v_permlane32_swap_b32 v250, v251
    v_sub_f32 v236, v236, v250
    v_sub_f32 v237, v237, v250
    v_sub_f32 v238, v238, v250
    v_sub_f32 v239, v239, v250
    v_sub_f32 v64, v64, v250
    v_sub_f32 v65, v65, v250
    v_sub_f32 v66, v66, v250
    v_sub_f32 v67, v67, v250
    v_sub_f32 v68, v68, v250
    v_sub_f32 v69, v69, v250
    v_sub_f32 v70, v70, v250
    v_sub_f32 v71, v71, v250
    v_sub_f32 v80, v80, v250
    v_sub_f32 v81, v81, v250
    v_sub_f32 v82, v82, v250
    v_sub_f32 v83, v83, v250
    v_sub_f32 v84, v84, v250
    v_sub_f32 v85, v85, v250
    v_sub_f32 v86, v86, v250
    v_sub_f32 v87, v87, v250
    v_sub_f32 v240, v240, v251
    v_sub_f32 v241, v241, v251
    v_sub_f32 v242, v242, v251
    v_sub_f32 v243, v243, v251
    v_sub_f32 v72, v72, v251
    v_sub_f32 v73, v73, v251
    v_sub_f32 v74, v74, v251
    v_sub_f32 v75, v75, v251
    v_sub_f32 v76, v76, v251
    v_sub_f32 v77, v77, v251
    v_sub_f32 v78, v78, v251
    v_sub_f32 v79, v79, v251
    v_sub_f32 v88, v88, v251
    v_sub_f32 v89, v89, v251
    v_sub_f32 v90, v90, v251
    v_sub_f32 v91, v91, v251
    v_sub_f32 v92, v92, v251
    v_sub_f32 v93, v93, v251
    v_sub_f32 v94, v94, v251
    v_sub_f32 v95, v95, v251
    v_exp_f32 v250, -v250
    v_exp_f32 v251, -v251
    s_nop 0
    v_mul_f32 v245, v245, v250
    v_mul_f32 v246, v246, v251
    v_mul_f32 v0, v0, v250
    v_mul_f32 v1, v1, v250
    v_mul_f32 v2, v2, v250
    v_mul_f32 v3, v3, v250
    v_mul_f32 v4, v4, v251
    v_mul_f32 v5, v5, v251
    v_mul_f32 v6, v6, v251
    v_mul_f32 v7, v7, v251
    v_mul_f32 v8, v8, v250
    v_mul_f32 v9, v9, v250
    v_mul_f32 v10, v10, v250
    v_mul_f32 v11, v11, v250
    v_mul_f32 v12, v12, v251
    v_mul_f32 v13, v13, v251
    v_mul_f32 v14, v14, v251
    v_mul_f32 v15, v15, v251
    v_mul_f32 v16, v16, v250
    v_mul_f32 v17, v17, v250
    v_mul_f32 v18, v18, v250
    v_mul_f32 v19, v19, v250
    v_mul_f32 v20, v20, v251
    v_mul_f32 v21, v21, v251
    v_mul_f32 v22, v22, v251
    v_mul_f32 v23, v23, v251
    v_mul_f32 v24, v24, v250
    v_mul_f32 v25, v25, v250
    v_mul_f32 v26, v26, v250
    v_mul_f32 v27, v27, v250
    v_mul_f32 v28, v28, v251
    v_mul_f32 v29, v29, v251
    v_mul_f32 v30, v30, v251
    v_mul_f32 v31, v31, v251
    v_mul_f32 v32, v32, v250
    v_mul_f32 v33, v33, v250
    v_mul_f32 v34, v34, v250
    v_mul_f32 v35, v35, v250
    v_mul_f32 v36, v36, v251
    v_mul_f32 v37, v37, v251
    v_mul_f32 v38, v38, v251
    v_mul_f32 v39, v39, v251
    v_mul_f32 v40, v40, v250
    v_mul_f32 v41, v41, v250
    v_mul_f32 v42, v42, v250
    v_mul_f32 v43, v43, v250
    v_mul_f32 v44, v44, v251
    v_mul_f32 v45, v45, v251
    v_mul_f32 v46, v46, v251
    v_mul_f32 v47, v47, v251
    v_mul_f32 v48, v48, v250
    v_mul_f32 v49, v49, v250
    v_mul_f32 v50, v50, v250
    v_mul_f32 v51, v51, v250
    v_mul_f32 v52, v52, v251
    v_mul_f32 v53, v53, v251
    v_mul_f32 v54, v54, v251
    v_mul_f32 v55, v55, v251
    v_mul_f32 v56, v56, v250
    v_mul_f32 v57, v57, v250
    v_mul_f32 v58, v58, v250
    v_mul_f32 v59, v59, v250
    v_mul_f32 v60, v60, v251
    v_mul_f32 v61, v61, v251
    v_mul_f32 v62, v62, v251
    v_mul_f32 v63, v63, v251
    s_nop 1
    s_branch L_back_b
L_stop:
.section .rodata,"a"
.p2align 6
.amdhsa_kernel standalone__gqa_block_cached__near_ridge_kernel
  .amdhsa_next_free_vgpr 256
  .amdhsa_next_free_sgpr 100
  .amdhsa_accum_offset 256
  .amdhsa_group_segment_fixed_size 0
  .amdhsa_kernarg_size 64
  .amdhsa_user_sgpr_count 2
  .amdhsa_user_sgpr_kernarg_segment_ptr 1
  .amdhsa_system_sgpr_workgroup_id_x 1
.end_amdhsa_kernel
```
